```python
import torch

def _softmax(x, axis=-1):
    return torch.softmax(x, dim=axis)
def _gelu(x):
    return torch.nn.functional.gelu(x, approximate="tanh")
def _silu(x):
    return torch.nn.functional.silu(x)
def _sigmoid(x):
    return torch.sigmoid(x)
def _layernorm(x, axis=-1, eps=1e-5):
    m = x.mean(dim=axis, keepdim=True)
    v = x.var(dim=axis, keepdim=True, unbiased=False)
    return (x - m) / torch.sqrt(v + eps)
def _scatter_add(tgt, idx, src, axis=0):
    return tgt.clone().index_add_(axis, idx, src)
def _segment_sum(src, seg, n):
    out = torch.zeros((n,) + src.shape[1:], dtype=src.dtype)
    return out.index_add_(0, seg, src)
def _pad(x, pw):
    flat = tuple(v for pair in reversed(pw) for v in pair)
    return torch.nn.functional.pad(x, flat)

kernel_name = 'interleave_layers__mha_block_cached__compressed_kv_cla__decode'

def setup_inputs():

    _w = (lambda a: (lambda t: t.to(torch.bfloat16) if t.is_floating_point() else t)(torch.as_tensor(a)))
    def _A_setup():
        B, Sq, D = 2, 1, 512
        H, Sk, Dh = 32, 4096, 128
        return {
            "x": _w((lambda *s: torch.randn(*s, dtype=torch.bfloat16) * 0.1)(B, Sq, D)),
            "k_cache": _w((lambda *s: torch.randn(*s, dtype=torch.bfloat16) * 0.8)(B, H, Sk, Dh)),
            "v_cache": _w((lambda *s: torch.randn(*s, dtype=torch.bfloat16) * 1.6)(B, H, Sk, Dh)),
            "wq": _w((lambda *s: torch.randn(*s, dtype=torch.bfloat16) * 0.8)(D, H * Dh) * (D ** -0.5)),
            "wo": _w((lambda *s: torch.randn(*s, dtype=torch.bfloat16) * 1.6)(H * Dh, D) * ((H * Dh) ** -0.5)),
        }
    _A_in = _A_setup()

    def _B_setup():
        B, H, Sq, Sk, D, M = 2, 32, 1, 4096, 128, 512
        Dc = 4 * D
        return {
            "x": _w((lambda *s: torch.randn(*s, dtype=torch.bfloat16) * 0.1)(B, Sq, M)),
            "c_kv": _w((lambda *s: torch.randn(*s, dtype=torch.bfloat16) * 0.8)(B, Sk, Dc)),
            "w_q": _w((lambda *s: torch.randn(*s, dtype=torch.bfloat16) * 1.6)(M, H, D) * (M ** -0.5)),
            "w_uk": _w((lambda *s: torch.randn(*s, dtype=torch.bfloat16) * 1.6)(Dc, H, D) * (Dc ** -0.5)),
            "w_uv": _w((lambda *s: torch.randn(*s, dtype=torch.bfloat16) * 0.8)(Dc, H, D) * (Dc ** -0.5)),
            "w_o": _w((lambda *s: torch.randn(*s, dtype=torch.bfloat16) * 0.8)(H, D, M) * ((H * D) ** -0.5)),
        }
    _B_in = _B_setup()

    return {
        "A_x": _A_in["x"],
        "A_k_cache": _A_in["k_cache"],
        "A_v_cache": _A_in["v_cache"],
        "A_wq": _A_in["wq"],
        "A_wo": _A_in["wo"],
        "B_x": _B_in["x"],
        "B_c_kv": _B_in["c_kv"],
        "B_w_q": _B_in["w_q"],
        "B_w_uk": _B_in["w_uk"],
        "B_w_uv": _B_in["w_uv"],
        "B_w_o": _B_in["w_o"],
    }

def reference(A_x, A_k_cache, A_v_cache, A_wq, A_wo, B_x, B_c_kv, B_w_q, B_w_uk, B_w_uv, B_w_o):
    def _A_ref(x, k_cache, v_cache, wq, wo):
        B, Sq, D = x.shape
        H, Dh = 32, 128
        q = (lambda x, *d: x.permute(*d))((x @ wq).reshape(B, Sq, H, Dh), 0, 2, 1, 3)
        scores = torch.einsum("bhqd,bhkd->bhqk", q, k_cache) * (Dh ** -0.5)
        p = _softmax(scores, axis=-1)
        o = torch.einsum("bhqk,bhkd->bhqd", p, v_cache)
        return (lambda x, *d: x.permute(*d))(o, 0, 2, 1, 3).reshape(B, Sq, H * Dh) @ wo

    def _B_ref(x, c_kv, w_q, w_uk, w_uv, w_o):
        B, Sq, M = x.shape[0], x.shape[1], x.shape[2]
        Sk = c_kv.shape[1]
        H, D = w_q.shape[1], w_q.shape[2]
        q = torch.einsum("bqm,mhd->bhqd", x, w_q)
        k = torch.einsum("bkc,chd->bhkd", c_kv, w_uk)
        v = torch.einsum("bkc,chd->bhkd", c_kv, w_uv)
        scores = torch.einsum("bhqd,bhkd->bhqk", q, k) * (D ** -0.5)
        off = Sk - Sq
        qi = torch.arange(Sq)[:, None]
        kj = torch.arange(Sk)[None, :]
        cmask = kj <= (qi + off)
        scores = torch.where(cmask[None, None], scores, -1e9)
        p = _softmax(scores, axis=-1)
        ctx = torch.einsum("bhqk,bhkd->bhqd", p, v)
        return torch.einsum("bhqd,hdm->bqm", ctx, w_o)

    x = A_x
    x = x + _A_ref(_layernorm(x, axis=-1), A_k_cache, A_v_cache, A_wq, A_wo)
    x = x + _B_ref(_layernorm(x, axis=-1), B_c_kv, B_w_q, B_w_uk, B_w_uv, B_w_o)
    x = x + _A_ref(_layernorm(x, axis=-1), A_k_cache, A_v_cache, A_wq, A_wo)
    x = x + _B_ref(_layernorm(x, axis=-1), B_c_kv, B_w_q, B_w_uk, B_w_uv, B_w_o)
    return x
```

```asm
; @launch grid=(256,1,1) block=(256,1,1) lds=163840
.amdgcn_target "amdgcn-amd-amdhsa--gfx950"
.text
.globl interleave_layers__mha_block_cached__compressed_kv_cla__decode_kernel
.p2align 8
.type interleave_layers__mha_block_cached__compressed_kv_cla__decode_kernel,@function
interleave_layers__mha_block_cached__compressed_kv_cla__decode_kernel:
s_cmp_ge_u32 s2, 256
s_cbranch_scc1 L_end
s_load_dwordx16 s[64:79], s[0:1], 0
s_load_dwordx8 s[80:87], s[0:1], 64
s_load_dwordx4 s[88:91], s[0:1], 96
v_lshrrev_b32 v1, 6, v0
s_nop 0
v_readfirstlane_b32 s62, v1
v_lshlrev_b32 v0, 4, v0
s_lshr_b32 s61, s2, 5
s_and_b32 s3, s2, 7
s_lshl_b32 s3, s3, 2
s_bfe_u32 s60, s2, 0x20003
s_or_b32 s60, s60, s3
s_waitcnt lgkmcnt(0)
s_mov_b32 s16, s90
s_mov_b32 s17, s91
s_mov_b32 s18, 268435456
s_mov_b32 s19, 0x20000
s_mov_b32 s52, s64
s_mov_b32 s53, s65
s_mov_b32 s54, 2048
s_mov_b32 s55, 0x20000
s_mov_b32 s48, s86
s_mov_b32 s49, s87
s_mov_b32 s50, 2048
s_mov_b32 s51, 0x20000
s_mov_b32 s56, s88
s_mov_b32 s57, s89
s_mov_b32 s58, 256
s_mov_b32 s59, 0x20000
v_mov_b32 v8, -1
v_mov_b32 v9, -1
v_mov_b32 v10, -1
v_mov_b32 v11, -1
s_mul_i32 s3, s2, 10240
buffer_store_dwordx4 v[8:11], v0, s[16:19], s3 offen sc1
s_add_u32 s3, s3, 4096
buffer_store_dwordx4 v[8:11], v0, s[16:19], s3 offen sc1
s_add_u32 s3, s3, 2048
buffer_store_dwordx4 v[8:11], v0, s[16:19], s3 offen sc1
s_add_u32 s3, s3, 2048
s_mul_i32 s3, s2, 10240
s_add_u32 s3, s3, 12582912
buffer_store_dwordx4 v[8:11], v0, s[16:19], s3 offen sc1
s_add_u32 s3, s3, 4096
buffer_store_dwordx4 v[8:11], v0, s[16:19], s3 offen sc1
s_add_u32 s3, s3, 2048
buffer_store_dwordx4 v[8:11], v0, s[16:19], s3 offen sc1
s_add_u32 s3, s3, 2048
s_lshr_b32 s63, s61, 2
s_lshl_b32 s3, s63, 10
v_bfe_u32 v13, v0, 8, 4
v_lshlrev_b32 v13, 6, v13
buffer_load_dwordx4 v[24:27], v13, s[52:55], s3 offen offset:0
buffer_load_dwordx4 v[28:31], v13, s[52:55], s3 offen offset:16
buffer_load_dwordx4 v[32:35], v13, s[52:55], s3 offen offset:32
buffer_load_dwordx4 v[36:39], v13, s[52:55], s3 offen offset:48
v_bfe_u32 v14, v0, 4, 6
v_lshlrev_b32 v14, 4, v14
buffer_load_dwordx4 v[40:43], v14, s[52:55], s3 offen
v_bfe_u32 v15, v0, 8, 4
v_lshlrev_b32 v15, 3, v15
v_bfe_u32 v47, v0, 7, 1
v_lshl_add_u32 v15, v47, 10, v15
s_lshl_b32 s3, s61, 7
buffer_load_dwordx2 v[4:5], v15, s[52:55], s3 offen
s_lshl_b32 s3, s60, 8
s_add_u32 s20, s70, s3
s_addc_u32 s21, s71, 0
s_sub_u32 s22, 4194304, s3
s_mov_b32 s23, 0x20000
v_bfe_u32 v16, v0, 4, 4
v_lshlrev_b32 v16, 4, v16
v_bfe_u32 v47, v0, 8, 4
v_lshl_add_u32 v16, v47, 18, v16
s_lshl_b32 s3, s63, 5
s_add_u32 s3, s3, s60
s_lshl_b32 s3, s3, 2
s_and_b32 s4, s61, 3
s_add_u32 s3, s3, s4
s_lshl_b32 s3, s3, 18
s_add_u32 s8, s66, s3
s_addc_u32 s9, s67, 0
s_sub_u32 s10, 67108864, s3
s_mov_b32 s11, 0x20000
s_add_u32 s12, s68, s3
s_addc_u32 s13, s69, 0
s_sub_u32 s14, 67108864, s3
s_mov_b32 s15, 0x20000
v_bfe_u32 v62, v0, 4, 2
v_lshlrev_b32 v62, 4, v62
v_bfe_u32 v47, v0, 6, 2
v_lshl_add_u32 v62, v47, 10, v62
v_bfe_u32 v47, v0, 8, 2
v_lshl_add_u32 v62, v47, 6, v62
v_bfe_u32 v47, v0, 10, 2
v_lshl_add_u32 v62, v47, 16, v62
v_bfe_u32 v63, v0, 4, 4
v_lshlrev_b32 v63, 4, v63
v_bfe_u32 v47, v0, 8, 2
v_lshl_add_u32 v63, v47, 11, v63
v_bfe_u32 v47, v0, 10, 2
v_lshl_add_u32 v63, v47, 16, v63
s_mov_b32 s5, 0
buffer_load_dwordx4 a[0:3], v62, s[8:11], s5 offen offset:0 nt
buffer_load_dwordx4 a[64:67], v62, s[8:11], s5 offen offset:256 nt
s_mov_b32 s4, 0
buffer_load_dwordx4 v[128:131], v16, s[20:23], s4 offen
buffer_load_dwordx4 a[128:131], v62, s[8:11], s5 offen offset:512 nt
buffer_load_dwordx4 a[192:195], v62, s[8:11], s5 offen offset:768 nt
s_mov_b32 s4, 8192
buffer_load_dwordx4 v[132:135], v16, s[20:23], s4 offen
s_mov_b32 s5, 4096
buffer_load_dwordx4 a[16:19], v62, s[8:11], s5 offen offset:0 nt
buffer_load_dwordx4 a[80:83], v62, s[8:11], s5 offen offset:256 nt
s_mov_b32 s4, 16384
buffer_load_dwordx4 v[136:139], v16, s[20:23], s4 offen
buffer_load_dwordx4 a[144:147], v62, s[8:11], s5 offen offset:512 nt
buffer_load_dwordx4 a[208:211], v62, s[8:11], s5 offen offset:768 nt
s_mov_b32 s4, 24576
buffer_load_dwordx4 v[140:143], v16, s[20:23], s4 offen
s_mov_b32 s5, 8192
buffer_load_dwordx4 a[32:35], v62, s[8:11], s5 offen offset:0 nt
buffer_load_dwordx4 a[96:99], v62, s[8:11], s5 offen offset:256 nt
s_mov_b32 s4, 32768
buffer_load_dwordx4 v[144:147], v16, s[20:23], s4 offen
buffer_load_dwordx4 a[160:163], v62, s[8:11], s5 offen offset:512 nt
buffer_load_dwordx4 a[224:227], v62, s[8:11], s5 offen offset:768 nt
s_mov_b32 s4, 40960
buffer_load_dwordx4 v[148:151], v16, s[20:23], s4 offen
s_mov_b32 s5, 12288
buffer_load_dwordx4 a[48:51], v62, s[8:11], s5 offen offset:0 nt
buffer_load_dwordx4 a[112:115], v62, s[8:11], s5 offen offset:256 nt
s_mov_b32 s4, 49152
buffer_load_dwordx4 v[152:155], v16, s[20:23], s4 offen
buffer_load_dwordx4 a[176:179], v62, s[8:11], s5 offen offset:512 nt
buffer_load_dwordx4 a[240:243], v62, s[8:11], s5 offen offset:768 nt
s_mov_b32 s4, 57344
buffer_load_dwordx4 v[156:159], v16, s[20:23], s4 offen
s_mov_b32 s5, 16384
buffer_load_dwordx4 a[4:7], v62, s[8:11], s5 offen offset:0 nt
buffer_load_dwordx4 a[68:71], v62, s[8:11], s5 offen offset:256 nt
s_mov_b32 s4, 65536
buffer_load_dwordx4 v[160:163], v16, s[20:23], s4 offen
buffer_load_dwordx4 a[132:135], v62, s[8:11], s5 offen offset:512 nt
buffer_load_dwordx4 a[196:199], v62, s[8:11], s5 offen offset:768 nt
s_mov_b32 s4, 73728
buffer_load_dwordx4 v[164:167], v16, s[20:23], s4 offen
s_mov_b32 s5, 20480
buffer_load_dwordx4 a[20:23], v62, s[8:11], s5 offen offset:0 nt
buffer_load_dwordx4 a[84:87], v62, s[8:11], s5 offen offset:256 nt
s_mov_b32 s4, 81920
buffer_load_dwordx4 v[168:171], v16, s[20:23], s4 offen
buffer_load_dwordx4 a[148:151], v62, s[8:11], s5 offen offset:512 nt
buffer_load_dwordx4 a[212:215], v62, s[8:11], s5 offen offset:768 nt
s_mov_b32 s4, 90112
buffer_load_dwordx4 v[172:175], v16, s[20:23], s4 offen
s_mov_b32 s5, 24576
buffer_load_dwordx4 a[36:39], v62, s[8:11], s5 offen offset:0 nt
buffer_load_dwordx4 a[100:103], v62, s[8:11], s5 offen offset:256 nt
s_mov_b32 s4, 98304
buffer_load_dwordx4 v[176:179], v16, s[20:23], s4 offen
buffer_load_dwordx4 a[164:167], v62, s[8:11], s5 offen offset:512 nt
buffer_load_dwordx4 a[228:231], v62, s[8:11], s5 offen offset:768 nt
s_mov_b32 s4, 106496
buffer_load_dwordx4 v[180:183], v16, s[20:23], s4 offen
s_mov_b32 s5, 28672
buffer_load_dwordx4 a[52:55], v62, s[8:11], s5 offen offset:0 nt
buffer_load_dwordx4 a[116:119], v62, s[8:11], s5 offen offset:256 nt
s_mov_b32 s4, 114688
buffer_load_dwordx4 v[184:187], v16, s[20:23], s4 offen
buffer_load_dwordx4 a[180:183], v62, s[8:11], s5 offen offset:512 nt
buffer_load_dwordx4 a[244:247], v62, s[8:11], s5 offen offset:768 nt
s_mov_b32 s4, 122880
buffer_load_dwordx4 v[188:191], v16, s[20:23], s4 offen
s_lshl_b32 s3, s61, 19
s_lshl_b32 s4, s60, 8
s_add_u32 s3, s3, s4
s_add_u32 s28, s78, s3
s_addc_u32 s29, s79, 0
s_sub_u32 s30, 4194304, s3
s_mov_b32 s31, 0x20000
s_add_u32 s32, s80, s3
s_addc_u32 s33, s81, 0
s_sub_u32 s34, 4194304, s3
s_mov_b32 s35, 0x20000
s_lshr_b32 s3, s61, 1
s_lshl_b32 s3, s3, 20
s_add_u32 s4, s4, s3
s_and_b32 s3, s61, 1
s_lshl_b32 s3, s3, 16
s_add_u32 s3, s3, s4
s_add_u32 s36, s82, s3
s_addc_u32 s37, s83, 0
s_sub_u32 s38, 4194304, s3
s_mov_b32 s39, 0x20000
s_lshl_b32 s3, s60, 17
s_lshl_b32 s4, s61, 7
s_add_u32 s3, s3, s4
s_add_u32 s24, s72, s3
s_addc_u32 s25, s73, 0
s_sub_u32 s26, 4194304, s3
s_mov_b32 s27, 0x20000
s_add_u32 s40, s84, s3
s_addc_u32 s41, s85, 0
s_sub_u32 s42, 4194304, s3
s_mov_b32 s43, 0x20000
s_and_b32 s3, s2, 7
s_lshr_b32 s4, s2, 4
s_lshl_b32 s4, s4, 3
s_or_b32 s6, s3, s4
s_lshl_b32 s3, s6, 16
s_bfe_u32 s7, s2, 0x10003
s_add_u32 s44, s76, s3
s_addc_u32 s45, s77, 0
s_sub_u32 s46, 8388608, s3
s_mov_b32 s47, 0x20000
s_mov_b32 s64, 50529027
s_mov_b32 s65, 50529027
s_mov_b32 s66, 202116108
s_mov_b32 s67, 202116108
s_mov_b32 s68, 808464432
s_mov_b32 s69, 808464432
s_mov_b32 s70, 3233857728
s_mov_b32 s71, 3233857728
s_mov_b32 s72, 3342387
s_mov_b32 s73, 3342387
s_mov_b32 s74, 13369548
s_mov_b32 s75, 13369548
s_mov_b32 s96, 855651072
s_mov_b32 s97, 855651072
s_mov_b32 s98, 3422604288
s_mov_b32 s99, 3422604288
s_mov_b32 s82, 1040356334
s_mov_b32 s83, 0xffff0000
s_mov_b32 s84, 0x05040100
s_mov_b32 s85, 0x07060302
s_mov_b32 s86, 0
s_mov_b32 s87, 8192
s_mov_b32 s88, 16384
s_mov_b32 s89, 24576
s_mov_b32 s90, 4096
s_mov_b32 s91, 989855744
s_mov_b32 s92, 925353388
s_lshl_b32 s93, s60, 3
s_add_u32 s93, s93, s61
s_mov_b32 s76, 0xaaaaaaaa
s_mov_b32 s77, 0xaaaaaaaa
v_mov_b32 v1, 0x0c0c0100
v_mov_b32 v2, 0x01000c0c
v_cndmask_b32 v1, v1, v2, s[76:77]
v_mov_b32 v2, 0x0c0c0302
v_mov_b32 v17, 0x03020c0c
v_cndmask_b32 v2, v2, v17, s[76:77]
s_waitcnt vmcnt(48)
v_and_b32 v7, s83, v5
v_lshlrev_b32 v6, 16, v5
v_and_b32 v5, s83, v4
v_lshlrev_b32 v4, 16, v4
s_mov_b32 s76, 0xff00ff00
s_mov_b32 s77, 0xff00ff00
v_mov_b32 v17, 0x3f803f80
v_cndmask_b32 v24, v24, v17, s[76:77]
v_cndmask_b32 v25, v25, v17, s[76:77]
v_cndmask_b32 v26, v26, v17, s[76:77]
v_cndmask_b32 v27, v27, v17, s[76:77]
v_cndmask_b32 v28, v28, v17, s[76:77]
v_cndmask_b32 v29, v29, v17, s[76:77]
v_cndmask_b32 v30, v30, v17, s[76:77]
v_cndmask_b32 v31, v31, v17, s[76:77]
v_cndmask_b32 v32, v32, v17, s[76:77]
v_cndmask_b32 v33, v33, v17, s[76:77]
v_cndmask_b32 v34, v34, v17, s[76:77]
v_cndmask_b32 v35, v35, v17, s[76:77]
v_cndmask_b32 v36, v36, v17, s[76:77]
v_cndmask_b32 v37, v37, v17, s[76:77]
v_cndmask_b32 v38, v38, v17, s[76:77]
v_cndmask_b32 v39, v39, v17, s[76:77]
v_mov_b32 v20, 0
v_mov_b32 v21, 0
v_lshlrev_b32 v17, 16, v40
v_and_b32 v18, s83, v40
v_add_f32 v20, v20, v17
v_fmac_f32 v21, v17, v17
v_add_f32 v20, v20, v18
v_fmac_f32 v21, v18, v18
v_lshlrev_b32 v17, 16, v41
v_and_b32 v18, s83, v41
v_add_f32 v20, v20, v17
v_fmac_f32 v21, v17, v17
v_add_f32 v20, v20, v18
v_fmac_f32 v21, v18, v18
v_lshlrev_b32 v17, 16, v42
v_and_b32 v18, s83, v42
v_add_f32 v20, v20, v17
v_fmac_f32 v21, v17, v17
v_add_f32 v20, v20, v18
v_fmac_f32 v21, v18, v18
v_lshlrev_b32 v17, 16, v43
v_and_b32 v18, s83, v43
v_add_f32 v20, v20, v17
v_fmac_f32 v21, v17, v17
v_add_f32 v20, v20, v18
v_fmac_f32 v21, v18, v18
s_nop 0
v_add_f32_dpp v20, v20, v20 quad_perm:[1,0,3,2] row_mask:0xf bank_mask:0xf
v_add_f32_dpp v21, v21, v21 quad_perm:[1,0,3,2] row_mask:0xf bank_mask:0xf
s_nop 0
v_add_f32_dpp v20, v20, v20 quad_perm:[2,3,0,1] row_mask:0xf bank_mask:0xf
v_add_f32_dpp v21, v21, v21 quad_perm:[2,3,0,1] row_mask:0xf bank_mask:0xf
s_nop 0
v_add_f32_dpp v20, v20, v20 row_half_mirror row_mask:0xf bank_mask:0xf
v_add_f32_dpp v21, v21, v21 row_half_mirror row_mask:0xf bank_mask:0xf
s_nop 0
v_add_f32_dpp v20, v20, v20 row_mirror row_mask:0xf bank_mask:0xf
v_add_f32_dpp v21, v21, v21 row_mirror row_mask:0xf bank_mask:0xf
v_mov_b32 v17, v20
s_nop 1
v_permlane16_swap_b32 v20, v17
v_add_f32 v20, v20, v17
v_mov_b32 v17, v20
s_nop 1
v_permlane32_swap_b32 v20, v17
v_add_f32 v20, v20, v17
v_mov_b32 v17, v21
s_nop 1
v_permlane16_swap_b32 v21, v17
v_add_f32 v21, v21, v17
v_mov_b32 v17, v21
s_nop 1
v_permlane32_swap_b32 v21, v17
v_add_f32 v21, v21, v17
v_mul_f32 v20, s91, v20
v_mul_f32 v21, s91, v21
v_fma_f32 v21, -v20, v20, v21
v_max_f32 v21, 0, v21
v_add_f32 v21, s92, v21
v_rsq_f32 v21, v21
s_mov_b32 s5, 32768
buffer_load_dwordx4 a[8:11], v62, s[8:11], s5 offen offset:0 nt
buffer_load_dwordx4 a[72:75], v62, s[8:11], s5 offen offset:256 nt
s_mov_b32 s4, 131072
buffer_load_dwordx4 v[192:195], v16, s[20:23], s4 offen
buffer_load_dwordx4 a[136:139], v62, s[8:11], s5 offen offset:512 nt
buffer_load_dwordx4 a[200:203], v62, s[8:11], s5 offen offset:768 nt
s_mov_b32 s4, 139264
buffer_load_dwordx4 v[196:199], v16, s[20:23], s4 offen
s_mov_b32 s5, 36864
buffer_load_dwordx4 a[24:27], v62, s[8:11], s5 offen offset:0 nt
buffer_load_dwordx4 a[88:91], v62, s[8:11], s5 offen offset:256 nt
s_mov_b32 s4, 147456
buffer_load_dwordx4 v[200:203], v16, s[20:23], s4 offen
buffer_load_dwordx4 a[152:155], v62, s[8:11], s5 offen offset:512 nt
buffer_load_dwordx4 a[216:219], v62, s[8:11], s5 offen offset:768 nt
s_mov_b32 s4, 155648
buffer_load_dwordx4 v[204:207], v16, s[20:23], s4 offen
s_barrier
s_cmp_lg_u32 s62, 3
s_cbranch_scc1 S_1
s_mov_b64 exec, 1
s_and_b32 s3, s2, 15
s_lshl_b32 s3, s3, 4
v_mov_b32 v17, 1
v_mov_b32 v18, s3
buffer_atomic_add v17, v18, s[56:59], 0 offen sc1
s_mov_b64 exec, -1
S_1:
s_waitcnt vmcnt(48)
v_perm_b32 v17, v24, v24, v1
v_cndmask_b32 v8, 0, v17, s[64:65]
v_cndmask_b32 v9, 0, v17, s[66:67]
v_cndmask_b32 v10, 0, v17, s[68:69]
v_cndmask_b32 v11, 0, v17, s[70:71]
s_nop 1
v_mfma_f32_16x16x32_bf16 v[40:43], v[8:11], v[128:131], 0
v_perm_b32 v17, v24, v24, v2
v_cndmask_b32 v12, 0, v17, s[64:65]
v_cndmask_b32 v13, 0, v17, s[66:67]
v_cndmask_b32 v14, 0, v17, s[68:69]
v_cndmask_b32 v15, 0, v17, s[70:71]
s_nop 1
v_mfma_f32_16x16x32_bf16 v[40:43], v[12:15], v[132:135], v[40:43]
v_perm_b32 v17, v25, v25, v1
v_cndmask_b32 v8, 0, v17, s[64:65]
v_cndmask_b32 v9, 0, v17, s[66:67]
v_cndmask_b32 v10, 0, v17, s[68:69]
v_cndmask_b32 v11, 0, v17, s[70:71]
s_nop 1
v_mfma_f32_16x16x32_bf16 v[40:43], v[8:11], v[136:139], v[40:43]
v_perm_b32 v17, v25, v25, v2
v_cndmask_b32 v12, 0, v17, s[64:65]
v_cndmask_b32 v13, 0, v17, s[66:67]
v_cndmask_b32 v14, 0, v17, s[68:69]
v_cndmask_b32 v15, 0, v17, s[70:71]
s_nop 1
v_mfma_f32_16x16x32_bf16 v[40:43], v[12:15], v[140:143], v[40:43]
s_mov_b32 s5, 40960
buffer_load_dwordx4 a[40:43], v62, s[8:11], s5 offen offset:0 nt
buffer_load_dwordx4 a[104:107], v62, s[8:11], s5 offen offset:256 nt
s_mov_b32 s4, 163840
buffer_load_dwordx4 v[208:211], v16, s[20:23], s4 offen
buffer_load_dwordx4 a[168:171], v62, s[8:11], s5 offen offset:512 nt
buffer_load_dwordx4 a[232:235], v62, s[8:11], s5 offen offset:768 nt
s_mov_b32 s4, 172032
buffer_load_dwordx4 v[212:215], v16, s[20:23], s4 offen
s_mov_b32 s5, 45056
buffer_load_dwordx4 a[56:59], v62, s[8:11], s5 offen offset:0 nt
buffer_load_dwordx4 a[120:123], v62, s[8:11], s5 offen offset:256 nt
s_mov_b32 s4, 180224
buffer_load_dwordx4 v[216:219], v16, s[20:23], s4 offen
buffer_load_dwordx4 a[184:187], v62, s[8:11], s5 offen offset:512 nt
buffer_load_dwordx4 a[248:251], v62, s[8:11], s5 offen offset:768 nt
s_mov_b32 s4, 188416
buffer_load_dwordx4 v[220:223], v16, s[20:23], s4 offen
s_waitcnt vmcnt(48)
v_perm_b32 v17, v26, v26, v1
v_cndmask_b32 v8, 0, v17, s[64:65]
v_cndmask_b32 v9, 0, v17, s[66:67]
v_cndmask_b32 v10, 0, v17, s[68:69]
v_cndmask_b32 v11, 0, v17, s[70:71]
s_nop 1
v_mfma_f32_16x16x32_bf16 v[40:43], v[8:11], v[144:147], v[40:43]
v_perm_b32 v17, v26, v26, v2
v_cndmask_b32 v12, 0, v17, s[64:65]
v_cndmask_b32 v13, 0, v17, s[66:67]
v_cndmask_b32 v14, 0, v17, s[68:69]
v_cndmask_b32 v15, 0, v17, s[70:71]
s_nop 1
v_mfma_f32_16x16x32_bf16 v[40:43], v[12:15], v[148:151], v[40:43]
v_perm_b32 v17, v27, v27, v1
v_cndmask_b32 v8, 0, v17, s[64:65]
v_cndmask_b32 v9, 0, v17, s[66:67]
v_cndmask_b32 v10, 0, v17, s[68:69]
v_cndmask_b32 v11, 0, v17, s[70:71]
s_nop 1
v_mfma_f32_16x16x32_bf16 v[40:43], v[8:11], v[152:155], v[40:43]
v_perm_b32 v17, v27, v27, v2
v_cndmask_b32 v12, 0, v17, s[64:65]
v_cndmask_b32 v13, 0, v17, s[66:67]
v_cndmask_b32 v14, 0, v17, s[68:69]
v_cndmask_b32 v15, 0, v17, s[70:71]
s_nop 1
v_mfma_f32_16x16x32_bf16 v[40:43], v[12:15], v[156:159], v[40:43]
s_mov_b32 s5, 49152
buffer_load_dwordx4 a[12:15], v62, s[8:11], s5 offen offset:0 nt
buffer_load_dwordx4 a[76:79], v62, s[8:11], s5 offen offset:256 nt
s_mov_b32 s4, 196608
buffer_load_dwordx4 v[224:227], v16, s[20:23], s4 offen
buffer_load_dwordx4 a[140:143], v62, s[8:11], s5 offen offset:512 nt
buffer_load_dwordx4 a[204:207], v62, s[8:11], s5 offen offset:768 nt
s_mov_b32 s4, 204800
buffer_load_dwordx4 v[228:231], v16, s[20:23], s4 offen
s_mov_b32 s5, 53248
buffer_load_dwordx4 a[28:31], v62, s[8:11], s5 offen offset:0 nt
buffer_load_dwordx4 a[92:95], v62, s[8:11], s5 offen offset:256 nt
s_mov_b32 s4, 212992
buffer_load_dwordx4 v[232:235], v16, s[20:23], s4 offen
buffer_load_dwordx4 a[156:159], v62, s[8:11], s5 offen offset:512 nt
buffer_load_dwordx4 a[220:223], v62, s[8:11], s5 offen offset:768 nt
s_mov_b32 s4, 221184
buffer_load_dwordx4 v[236:239], v16, s[20:23], s4 offen
s_waitcnt vmcnt(48)
v_perm_b32 v17, v28, v28, v1
v_cndmask_b32 v8, 0, v17, s[64:65]
v_cndmask_b32 v9, 0, v17, s[66:67]
v_cndmask_b32 v10, 0, v17, s[68:69]
v_cndmask_b32 v11, 0, v17, s[70:71]
s_nop 1
v_mfma_f32_16x16x32_bf16 v[40:43], v[8:11], v[160:163], v[40:43]
v_perm_b32 v17, v28, v28, v2
v_cndmask_b32 v12, 0, v17, s[64:65]
v_cndmask_b32 v13, 0, v17, s[66:67]
v_cndmask_b32 v14, 0, v17, s[68:69]
v_cndmask_b32 v15, 0, v17, s[70:71]
s_nop 1
v_mfma_f32_16x16x32_bf16 v[40:43], v[12:15], v[164:167], v[40:43]
v_perm_b32 v17, v29, v29, v1
v_cndmask_b32 v8, 0, v17, s[64:65]
v_cndmask_b32 v9, 0, v17, s[66:67]
v_cndmask_b32 v10, 0, v17, s[68:69]
v_cndmask_b32 v11, 0, v17, s[70:71]
s_nop 1
v_mfma_f32_16x16x32_bf16 v[40:43], v[8:11], v[168:171], v[40:43]
v_perm_b32 v17, v29, v29, v2
v_cndmask_b32 v12, 0, v17, s[64:65]
v_cndmask_b32 v13, 0, v17, s[66:67]
v_cndmask_b32 v14, 0, v17, s[68:69]
v_cndmask_b32 v15, 0, v17, s[70:71]
s_nop 1
v_mfma_f32_16x16x32_bf16 v[40:43], v[12:15], v[172:175], v[40:43]
s_mov_b32 s5, 57344
buffer_load_dwordx4 a[44:47], v62, s[8:11], s5 offen offset:0 nt
buffer_load_dwordx4 a[108:111], v62, s[8:11], s5 offen offset:256 nt
s_mov_b32 s4, 229376
buffer_load_dwordx4 v[240:243], v16, s[20:23], s4 offen
buffer_load_dwordx4 a[172:175], v62, s[8:11], s5 offen offset:512 nt
buffer_load_dwordx4 a[236:239], v62, s[8:11], s5 offen offset:768 nt
s_mov_b32 s4, 237568
buffer_load_dwordx4 v[244:247], v16, s[20:23], s4 offen
s_mov_b32 s5, 61440
buffer_load_dwordx4 a[60:63], v62, s[8:11], s5 offen offset:0 nt
buffer_load_dwordx4 a[124:127], v62, s[8:11], s5 offen offset:256 nt
s_mov_b32 s4, 245760
buffer_load_dwordx4 v[248:251], v16, s[20:23], s4 offen
buffer_load_dwordx4 a[188:191], v62, s[8:11], s5 offen offset:512 nt
buffer_load_dwordx4 a[252:255], v62, s[8:11], s5 offen offset:768 nt
s_mov_b32 s4, 253952
buffer_load_dwordx4 v[252:255], v16, s[20:23], s4 offen
s_waitcnt vmcnt(48)
v_perm_b32 v17, v30, v30, v1
v_cndmask_b32 v8, 0, v17, s[64:65]
v_cndmask_b32 v9, 0, v17, s[66:67]
v_cndmask_b32 v10, 0, v17, s[68:69]
v_cndmask_b32 v11, 0, v17, s[70:71]
s_nop 1
v_mfma_f32_16x16x32_bf16 v[40:43], v[8:11], v[176:179], v[40:43]
v_perm_b32 v17, v30, v30, v2
v_cndmask_b32 v12, 0, v17, s[64:65]
v_cndmask_b32 v13, 0, v17, s[66:67]
v_cndmask_b32 v14, 0, v17, s[68:69]
v_cndmask_b32 v15, 0, v17, s[70:71]
s_nop 1
v_mfma_f32_16x16x32_bf16 v[40:43], v[12:15], v[180:183], v[40:43]
v_perm_b32 v17, v31, v31, v1
v_cndmask_b32 v8, 0, v17, s[64:65]
v_cndmask_b32 v9, 0, v17, s[66:67]
v_cndmask_b32 v10, 0, v17, s[68:69]
v_cndmask_b32 v11, 0, v17, s[70:71]
s_nop 1
v_mfma_f32_16x16x32_bf16 v[40:43], v[8:11], v[184:187], v[40:43]
v_perm_b32 v17, v31, v31, v2
v_cndmask_b32 v12, 0, v17, s[64:65]
v_cndmask_b32 v13, 0, v17, s[66:67]
v_cndmask_b32 v14, 0, v17, s[68:69]
v_cndmask_b32 v15, 0, v17, s[70:71]
s_nop 1
v_mfma_f32_16x16x32_bf16 v[40:43], v[12:15], v[188:191], v[40:43]
s_mov_b32 s5, 0
buffer_load_dwordx4 v[64:67], v63, s[12:15], s5 offen offset:0 nt
buffer_load_dwordx4 v[68:71], v63, s[12:15], s5 offen offset:256 nt
buffer_load_dwordx4 v[72:75], v63, s[12:15], s5 offen offset:512 nt
buffer_load_dwordx4 v[76:79], v63, s[12:15], s5 offen offset:768 nt
buffer_load_dwordx4 v[80:83], v63, s[12:15], s5 offen offset:1024 nt
buffer_load_dwordx4 v[84:87], v63, s[12:15], s5 offen offset:1280 nt
buffer_load_dwordx4 v[88:91], v63, s[12:15], s5 offen offset:1536 nt
buffer_load_dwordx4 v[92:95], v63, s[12:15], s5 offen offset:1792 nt
s_waitcnt vmcnt(44)
v_perm_b32 v17, v32, v32, v1
v_cndmask_b32 v8, 0, v17, s[64:65]
v_cndmask_b32 v9, 0, v17, s[66:67]
v_cndmask_b32 v10, 0, v17, s[68:69]
v_cndmask_b32 v11, 0, v17, s[70:71]
s_nop 1
v_mfma_f32_16x16x32_bf16 v[40:43], v[8:11], v[192:195], v[40:43]
v_perm_b32 v17, v32, v32, v2
v_cndmask_b32 v12, 0, v17, s[64:65]
v_cndmask_b32 v13, 0, v17, s[66:67]
v_cndmask_b32 v14, 0, v17, s[68:69]
v_cndmask_b32 v15, 0, v17, s[70:71]
s_nop 1
v_mfma_f32_16x16x32_bf16 v[40:43], v[12:15], v[196:199], v[40:43]
v_perm_b32 v17, v33, v33, v1
v_cndmask_b32 v8, 0, v17, s[64:65]
v_cndmask_b32 v9, 0, v17, s[66:67]
v_cndmask_b32 v10, 0, v17, s[68:69]
v_cndmask_b32 v11, 0, v17, s[70:71]
s_nop 1
v_mfma_f32_16x16x32_bf16 v[40:43], v[8:11], v[200:203], v[40:43]
v_perm_b32 v17, v33, v33, v2
v_cndmask_b32 v12, 0, v17, s[64:65]
v_cndmask_b32 v13, 0, v17, s[66:67]
v_cndmask_b32 v14, 0, v17, s[68:69]
v_cndmask_b32 v15, 0, v17, s[70:71]
s_nop 1
v_mfma_f32_16x16x32_bf16 v[40:43], v[12:15], v[204:207], v[40:43]
s_mov_b32 s5, 8192
buffer_load_dwordx4 v[96:99], v63, s[12:15], s5 offen offset:0 nt
buffer_load_dwordx4 v[100:103], v63, s[12:15], s5 offen offset:256 nt
buffer_load_dwordx4 v[104:107], v63, s[12:15], s5 offen offset:512 nt
buffer_load_dwordx4 v[108:111], v63, s[12:15], s5 offen offset:768 nt
buffer_load_dwordx4 v[112:115], v63, s[12:15], s5 offen offset:1024 nt
buffer_load_dwordx4 v[116:119], v63, s[12:15], s5 offen offset:1280 nt
buffer_load_dwordx4 v[120:123], v63, s[12:15], s5 offen offset:1536 nt
buffer_load_dwordx4 v[124:127], v63, s[12:15], s5 offen offset:1792 nt
s_waitcnt vmcnt(40)
v_perm_b32 v17, v34, v34, v1
v_cndmask_b32 v8, 0, v17, s[64:65]
v_cndmask_b32 v9, 0, v17, s[66:67]
v_cndmask_b32 v10, 0, v17, s[68:69]
v_cndmask_b32 v11, 0, v17, s[70:71]
s_nop 1
v_mfma_f32_16x16x32_bf16 v[40:43], v[8:11], v[208:211], v[40:43]
v_perm_b32 v17, v34, v34, v2
v_cndmask_b32 v12, 0, v17, s[64:65]
v_cndmask_b32 v13, 0, v17, s[66:67]
v_cndmask_b32 v14, 0, v17, s[68:69]
v_cndmask_b32 v15, 0, v17, s[70:71]
s_nop 1
v_mfma_f32_16x16x32_bf16 v[40:43], v[12:15], v[212:215], v[40:43]
v_perm_b32 v17, v35, v35, v1
v_cndmask_b32 v8, 0, v17, s[64:65]
v_cndmask_b32 v9, 0, v17, s[66:67]
v_cndmask_b32 v10, 0, v17, s[68:69]
v_cndmask_b32 v11, 0, v17, s[70:71]
s_nop 1
v_mfma_f32_16x16x32_bf16 v[40:43], v[8:11], v[216:219], v[40:43]
v_perm_b32 v17, v35, v35, v2
v_cndmask_b32 v12, 0, v17, s[64:65]
v_cndmask_b32 v13, 0, v17, s[66:67]
v_cndmask_b32 v14, 0, v17, s[68:69]
v_cndmask_b32 v15, 0, v17, s[70:71]
s_nop 1
v_mfma_f32_16x16x32_bf16 v[40:43], v[12:15], v[220:223], v[40:43]
s_mov_b32 s5, 16384
buffer_load_dwordx4 v[128:131], v63, s[12:15], s5 offen offset:0 nt
buffer_load_dwordx4 v[132:135], v63, s[12:15], s5 offen offset:256 nt
buffer_load_dwordx4 v[136:139], v63, s[12:15], s5 offen offset:512 nt
buffer_load_dwordx4 v[140:143], v63, s[12:15], s5 offen offset:768 nt
buffer_load_dwordx4 v[144:147], v63, s[12:15], s5 offen offset:1024 nt
buffer_load_dwordx4 v[148:151], v63, s[12:15], s5 offen offset:1280 nt
buffer_load_dwordx4 v[152:155], v63, s[12:15], s5 offen offset:1536 nt
buffer_load_dwordx4 v[156:159], v63, s[12:15], s5 offen offset:1792 nt
s_waitcnt vmcnt(36)
v_perm_b32 v17, v36, v36, v1
v_cndmask_b32 v8, 0, v17, s[64:65]
v_cndmask_b32 v9, 0, v17, s[66:67]
v_cndmask_b32 v10, 0, v17, s[68:69]
v_cndmask_b32 v11, 0, v17, s[70:71]
s_nop 1
v_mfma_f32_16x16x32_bf16 v[40:43], v[8:11], v[224:227], v[40:43]
v_perm_b32 v17, v36, v36, v2
v_cndmask_b32 v12, 0, v17, s[64:65]
v_cndmask_b32 v13, 0, v17, s[66:67]
v_cndmask_b32 v14, 0, v17, s[68:69]
v_cndmask_b32 v15, 0, v17, s[70:71]
s_nop 1
v_mfma_f32_16x16x32_bf16 v[40:43], v[12:15], v[228:231], v[40:43]
v_perm_b32 v17, v37, v37, v1
v_cndmask_b32 v8, 0, v17, s[64:65]
v_cndmask_b32 v9, 0, v17, s[66:67]
v_cndmask_b32 v10, 0, v17, s[68:69]
v_cndmask_b32 v11, 0, v17, s[70:71]
s_nop 1
v_mfma_f32_16x16x32_bf16 v[40:43], v[8:11], v[232:235], v[40:43]
v_perm_b32 v17, v37, v37, v2
v_cndmask_b32 v12, 0, v17, s[64:65]
v_cndmask_b32 v13, 0, v17, s[66:67]
v_cndmask_b32 v14, 0, v17, s[68:69]
v_cndmask_b32 v15, 0, v17, s[70:71]
s_nop 1
v_mfma_f32_16x16x32_bf16 v[40:43], v[12:15], v[236:239], v[40:43]
s_mov_b32 s5, 24576
buffer_load_dwordx4 v[160:163], v63, s[12:15], s5 offen offset:0 nt
buffer_load_dwordx4 v[164:167], v63, s[12:15], s5 offen offset:256 nt
buffer_load_dwordx4 v[168:171], v63, s[12:15], s5 offen offset:512 nt
buffer_load_dwordx4 v[172:175], v63, s[12:15], s5 offen offset:768 nt
buffer_load_dwordx4 v[176:179], v63, s[12:15], s5 offen offset:1024 nt
buffer_load_dwordx4 v[180:183], v63, s[12:15], s5 offen offset:1280 nt
buffer_load_dwordx4 v[184:187], v63, s[12:15], s5 offen offset:1536 nt
buffer_load_dwordx4 v[188:191], v63, s[12:15], s5 offen offset:1792 nt
s_waitcnt vmcnt(32)
v_perm_b32 v17, v38, v38, v1
v_cndmask_b32 v8, 0, v17, s[64:65]
v_cndmask_b32 v9, 0, v17, s[66:67]
v_cndmask_b32 v10, 0, v17, s[68:69]
v_cndmask_b32 v11, 0, v17, s[70:71]
s_nop 1
v_mfma_f32_16x16x32_bf16 v[40:43], v[8:11], v[240:243], v[40:43]
v_perm_b32 v17, v38, v38, v2
v_cndmask_b32 v12, 0, v17, s[64:65]
v_cndmask_b32 v13, 0, v17, s[66:67]
v_cndmask_b32 v14, 0, v17, s[68:69]
v_cndmask_b32 v15, 0, v17, s[70:71]
s_nop 1
v_mfma_f32_16x16x32_bf16 v[40:43], v[12:15], v[244:247], v[40:43]
v_perm_b32 v17, v39, v39, v1
v_cndmask_b32 v8, 0, v17, s[64:65]
v_cndmask_b32 v9, 0, v17, s[66:67]
v_cndmask_b32 v10, 0, v17, s[68:69]
v_cndmask_b32 v11, 0, v17, s[70:71]
s_nop 1
v_mfma_f32_16x16x32_bf16 v[40:43], v[8:11], v[248:251], v[40:43]
v_perm_b32 v17, v39, v39, v2
v_cndmask_b32 v12, 0, v17, s[64:65]
v_cndmask_b32 v13, 0, v17, s[66:67]
v_cndmask_b32 v14, 0, v17, s[68:69]
v_cndmask_b32 v15, 0, v17, s[70:71]
s_nop 1
v_mfma_f32_16x16x32_bf16 v[40:43], v[12:15], v[252:255], v[40:43]
s_mov_b32 s5, 32768
buffer_load_dwordx4 v[192:195], v63, s[12:15], s5 offen offset:0 nt
buffer_load_dwordx4 v[196:199], v63, s[12:15], s5 offen offset:256 nt
buffer_load_dwordx4 v[200:203], v63, s[12:15], s5 offen offset:512 nt
buffer_load_dwordx4 v[204:207], v63, s[12:15], s5 offen offset:768 nt
buffer_load_dwordx4 v[208:211], v63, s[12:15], s5 offen offset:1024 nt
buffer_load_dwordx4 v[212:215], v63, s[12:15], s5 offen offset:1280 nt
buffer_load_dwordx4 v[216:219], v63, s[12:15], s5 offen offset:1536 nt
buffer_load_dwordx4 v[220:223], v63, s[12:15], s5 offen offset:1792 nt
ds_write_b128 v0, v[40:43] offset:4096
s_waitcnt lgkmcnt(0)
s_barrier
s_mov_b32 s5, 40960
buffer_load_dwordx4 v[224:227], v63, s[12:15], s5 offen offset:0 nt
buffer_load_dwordx4 v[228:231], v63, s[12:15], s5 offen offset:256 nt
buffer_load_dwordx4 v[232:235], v63, s[12:15], s5 offen offset:512 nt
buffer_load_dwordx4 v[236:239], v63, s[12:15], s5 offen offset:768 nt
buffer_load_dwordx4 v[240:243], v63, s[12:15], s5 offen offset:1024 nt
buffer_load_dwordx4 v[244:247], v63, s[12:15], s5 offen offset:1280 nt
buffer_load_dwordx4 v[248:251], v63, s[12:15], s5 offen offset:1536 nt
buffer_load_dwordx4 v[252:255], v63, s[12:15], s5 offen offset:1792 nt
v_bfe_u32 v45, v0, 4, 6
v_lshlrev_b32 v45, 4, v45
v_add_u32 v45, 4096, v45
ds_read_b128 v[24:27], v45 offset:0
ds_read_b128 v[28:31], v45 offset:1024
ds_read_b128 v[32:35], v45 offset:2048
ds_read_b128 v[36:39], v45 offset:3072
s_waitcnt lgkmcnt(0)
v_add_f32 v24, v24, v28
v_add_f32 v32, v32, v36
v_add_f32 v24, v24, v32
v_mov_b32 v28, v24
v_add_f32 v25, v25, v29
v_add_f32 v33, v33, v37
v_add_f32 v25, v25, v33
v_mov_b32 v29, v25
v_add_f32 v26, v26, v30
v_add_f32 v34, v34, v38
v_add_f32 v26, v26, v34
v_mov_b32 v30, v26
v_add_f32 v27, v27, v31
v_add_f32 v35, v35, v39
v_add_f32 v27, v27, v35
v_mov_b32 v31, v27
v_permlane32_swap_b32 v24, v28
v_permlane32_swap_b32 v25, v29
v_permlane32_swap_b32 v26, v30
v_permlane32_swap_b32 v27, v31
v_bfe_u32 v45, v0, 4, 4
v_lshlrev_b32 v45, 5, v45
v_bfe_u32 v47, v0, 8, 1
v_lshl_add_u32 v45, v47, 4, v45
v_add_u32 v45, 29696, v45
ds_write_b128 v45, v[28:31]
v_fma_f32 v24, -v20, v28, v24
v_mul_f32 v24, v21, v24
v_fma_f32 v25, -v20, v29, v25
v_mul_f32 v25, v21, v25
v_fma_f32 v26, -v20, v30, v26
v_mul_f32 v26, v21, v26
v_fma_f32 v27, -v20, v31, v27
v_mul_f32 v27, v21, v27
v_cvt_pk_bf16_f32 v24, v24, v25
v_cvt_pk_bf16_f32 v25, v26, v27
v_bfe_u32 v45, v0, 4, 4
v_lshlrev_b32 v45, 4, v45
v_bfe_u32 v47, v0, 8, 1
v_lshl_add_u32 v45, v47, 3, v45
v_bfe_u32 v47, v0, 10, 2
v_lshl_add_u32 v45, v47, 8, v45
v_add_u32 v45, 8192, v45
ds_write_b64 v45, v[24:25]
v_bfe_u32 v45, v0, 4, 2
v_lshlrev_b32 v45, 4, v45
v_bfe_u32 v47, v0, 8, 4
v_lshl_add_u32 v45, v47, 6, v45
v_add_u32 v45, 8192, v45
s_waitcnt lgkmcnt(0)
ds_read_b128 v[40:43], v45
s_waitcnt lgkmcnt(0)
v_bfe_u32 v45, v0, 4, 4
v_lshlrev_b32 v45, 5, v45
v_bfe_u32 v47, v0, 8, 2
v_lshl_add_u32 v45, v47, 3, v45
v_bfe_u32 v47, v0, 10, 2
v_lshl_add_u32 v45, v47, 9, v45
v_add_u32 v45, 30720, v45
v_bfe_u32 v46, v0, 8, 2
v_lshlrev_b32 v46, 4, v46
v_bfe_u32 v47, v0, 10, 2
v_lshl_add_u32 v46, v47, 9, v46
v_add_u32 v46, 30720, v46
s_mov_b32 s76, 983055
s_mov_b32 s77, 983055
v_cndmask_b32 v8, 0, v40, s[76:77]
v_cndmask_b32 v9, 0, v41, s[76:77]
v_cndmask_b32 v10, 0, v42, s[76:77]
v_cndmask_b32 v11, 0, v43, s[76:77]
s_nop 1
v_mfma_f32_16x16x32_bf16 v[24:27], a[0:3], v[8:11], 0
s_mov_b32 s76, 15728880
s_mov_b32 s77, 15728880
v_cndmask_b32 v12, 0, v40, s[76:77]
v_cndmask_b32 v13, 0, v41, s[76:77]
v_cndmask_b32 v14, 0, v42, s[76:77]
v_cndmask_b32 v15, 0, v43, s[76:77]
s_nop 1
v_mfma_f32_16x16x32_bf16 v[24:27], a[4:7], v[12:15], v[24:27]
s_mov_b32 s76, 251662080
s_mov_b32 s77, 251662080
v_cndmask_b32 v16, 0, v40, s[76:77]
v_cndmask_b32 v17, 0, v41, s[76:77]
v_cndmask_b32 v18, 0, v42, s[76:77]
v_cndmask_b32 v19, 0, v43, s[76:77]
s_nop 1
v_mfma_f32_16x16x32_bf16 v[24:27], a[8:11], v[16:19], v[24:27]
s_mov_b32 s76, 4026593280
s_mov_b32 s77, 4026593280
v_cndmask_b32 v20, 0, v40, s[76:77]
v_cndmask_b32 v21, 0, v41, s[76:77]
v_cndmask_b32 v22, 0, v42, s[76:77]
v_cndmask_b32 v23, 0, v43, s[76:77]
s_nop 1
v_mfma_f32_16x16x32_bf16 v[24:27], a[12:15], v[20:23], v[24:27]
v_mfma_f32_16x16x32_bf16 v[28:31], a[16:19], v[8:11], 0
v_mfma_f32_16x16x32_bf16 v[28:31], a[20:23], v[12:15], v[28:31]
v_mfma_f32_16x16x32_bf16 v[28:31], a[24:27], v[16:19], v[28:31]
v_mfma_f32_16x16x32_bf16 v[28:31], a[28:31], v[20:23], v[28:31]
v_mfma_f32_16x16x32_bf16 v[32:35], a[32:35], v[8:11], 0
s_nop 2
v_mov_b32_dpp v40, v24 quad_perm:[0,0,0,0] row_mask:0xf bank_mask:0xf
s_mov_b32 s76, 286331153
s_mov_b32 s77, 286331153
v_mfma_f32_16x16x32_bf16 v[32:35], a[36:39], v[12:15], v[32:35]
v_add_f32_dpp v40, v25, v40 quad_perm:[1,1,1,1] row_mask:0xf bank_mask:0xf
v_mfma_f32_16x16x32_bf16 v[32:35], a[40:43], v[16:19], v[32:35]
v_add_f32_dpp v40, v26, v40 quad_perm:[2,2,2,2] row_mask:0xf bank_mask:0xf
v_mfma_f32_16x16x32_bf16 v[32:35], a[44:47], v[20:23], v[32:35]
v_add_f32_dpp v40, v27, v40 quad_perm:[3,3,3,3] row_mask:0xf bank_mask:0xf
v_cndmask_b32 v36, v36, v40, s[76:77]
v_mfma_f32_16x16x32_bf16 v[24:27], a[48:51], v[8:11], 0
v_mov_b32_dpp v40, v28 quad_perm:[0,0,0,0] row_mask:0xf bank_mask:0xf
s_mov_b32 s76, 572662306
s_mov_b32 s77, 572662306
v_mfma_f32_16x16x32_bf16 v[24:27], a[52:55], v[12:15], v[24:27]
v_add_f32_dpp v40, v29, v40 quad_perm:[1,1,1,1] row_mask:0xf bank_mask:0xf
v_mfma_f32_16x16x32_bf16 v[24:27], a[56:59], v[16:19], v[24:27]
v_add_f32_dpp v40, v30, v40 quad_perm:[2,2,2,2] row_mask:0xf bank_mask:0xf
v_mfma_f32_16x16x32_bf16 v[24:27], a[60:63], v[20:23], v[24:27]
v_add_f32_dpp v40, v31, v40 quad_perm:[3,3,3,3] row_mask:0xf bank_mask:0xf
v_cndmask_b32 v36, v36, v40, s[76:77]
v_mfma_f32_16x16x32_bf16 v[28:31], a[64:67], v[8:11], 0
v_mov_b32_dpp v40, v32 quad_perm:[0,0,0,0] row_mask:0xf bank_mask:0xf
s_mov_b32 s76, 1145324612
s_mov_b32 s77, 1145324612
v_mfma_f32_16x16x32_bf16 v[28:31], a[68:71], v[12:15], v[28:31]
v_add_f32_dpp v40, v33, v40 quad_perm:[1,1,1,1] row_mask:0xf bank_mask:0xf
v_mfma_f32_16x16x32_bf16 v[28:31], a[72:75], v[16:19], v[28:31]
v_add_f32_dpp v40, v34, v40 quad_perm:[2,2,2,2] row_mask:0xf bank_mask:0xf
v_mfma_f32_16x16x32_bf16 v[28:31], a[76:79], v[20:23], v[28:31]
v_add_f32_dpp v40, v35, v40 quad_perm:[3,3,3,3] row_mask:0xf bank_mask:0xf
v_cndmask_b32 v36, v36, v40, s[76:77]
v_mfma_f32_16x16x32_bf16 v[32:35], a[80:83], v[8:11], 0
v_mov_b32_dpp v40, v24 quad_perm:[0,0,0,0] row_mask:0xf bank_mask:0xf
s_mov_b32 s76, 2290649224
s_mov_b32 s77, 2290649224
v_mfma_f32_16x16x32_bf16 v[32:35], a[84:87], v[12:15], v[32:35]
v_add_f32_dpp v40, v25, v40 quad_perm:[1,1,1,1] row_mask:0xf bank_mask:0xf
v_mfma_f32_16x16x32_bf16 v[32:35], a[88:91], v[16:19], v[32:35]
v_add_f32_dpp v40, v26, v40 quad_perm:[2,2,2,2] row_mask:0xf bank_mask:0xf
v_mfma_f32_16x16x32_bf16 v[32:35], a[92:95], v[20:23], v[32:35]
v_add_f32_dpp v40, v27, v40 quad_perm:[3,3,3,3] row_mask:0xf bank_mask:0xf
v_cndmask_b32 v36, v36, v40, s[76:77]
v_mfma_f32_16x16x32_bf16 v[24:27], a[96:99], v[8:11], 0
v_mov_b32_dpp v40, v28 quad_perm:[0,0,0,0] row_mask:0xf bank_mask:0xf
s_mov_b32 s76, 286331153
s_mov_b32 s77, 286331153
v_mfma_f32_16x16x32_bf16 v[24:27], a[100:103], v[12:15], v[24:27]
v_add_f32_dpp v40, v29, v40 quad_perm:[1,1,1,1] row_mask:0xf bank_mask:0xf
v_mfma_f32_16x16x32_bf16 v[24:27], a[104:107], v[16:19], v[24:27]
v_add_f32_dpp v40, v30, v40 quad_perm:[2,2,2,2] row_mask:0xf bank_mask:0xf
v_mfma_f32_16x16x32_bf16 v[24:27], a[108:111], v[20:23], v[24:27]
v_add_f32_dpp v40, v31, v40 quad_perm:[3,3,3,3] row_mask:0xf bank_mask:0xf
v_cndmask_b32 v37, v37, v40, s[76:77]
v_mfma_f32_16x16x32_bf16 v[28:31], a[112:115], v[8:11], 0
v_mov_b32_dpp v40, v32 quad_perm:[0,0,0,0] row_mask:0xf bank_mask:0xf
s_mov_b32 s76, 572662306
s_mov_b32 s77, 572662306
v_mfma_f32_16x16x32_bf16 v[28:31], a[116:119], v[12:15], v[28:31]
v_add_f32_dpp v40, v33, v40 quad_perm:[1,1,1,1] row_mask:0xf bank_mask:0xf
v_mfma_f32_16x16x32_bf16 v[28:31], a[120:123], v[16:19], v[28:31]
v_add_f32_dpp v40, v34, v40 quad_perm:[2,2,2,2] row_mask:0xf bank_mask:0xf
v_mfma_f32_16x16x32_bf16 v[28:31], a[124:127], v[20:23], v[28:31]
v_add_f32_dpp v40, v35, v40 quad_perm:[3,3,3,3] row_mask:0xf bank_mask:0xf
v_cndmask_b32 v37, v37, v40, s[76:77]
v_mfma_f32_16x16x32_bf16 v[32:35], a[128:131], v[8:11], 0
v_mov_b32_dpp v40, v24 quad_perm:[0,0,0,0] row_mask:0xf bank_mask:0xf
s_mov_b32 s76, 1145324612
s_mov_b32 s77, 1145324612
v_mfma_f32_16x16x32_bf16 v[32:35], a[132:135], v[12:15], v[32:35]
v_add_f32_dpp v40, v25, v40 quad_perm:[1,1,1,1] row_mask:0xf bank_mask:0xf
v_mfma_f32_16x16x32_bf16 v[32:35], a[136:139], v[16:19], v[32:35]
v_add_f32_dpp v40, v26, v40 quad_perm:[2,2,2,2] row_mask:0xf bank_mask:0xf
v_mfma_f32_16x16x32_bf16 v[32:35], a[140:143], v[20:23], v[32:35]
v_add_f32_dpp v40, v27, v40 quad_perm:[3,3,3,3] row_mask:0xf bank_mask:0xf
v_cndmask_b32 v37, v37, v40, s[76:77]
v_mfma_f32_16x16x32_bf16 v[24:27], a[144:147], v[8:11], 0
v_mov_b32_dpp v40, v28 quad_perm:[0,0,0,0] row_mask:0xf bank_mask:0xf
s_mov_b32 s76, 2290649224
s_mov_b32 s77, 2290649224
v_mfma_f32_16x16x32_bf16 v[24:27], a[148:151], v[12:15], v[24:27]
v_add_f32_dpp v40, v29, v40 quad_perm:[1,1,1,1] row_mask:0xf bank_mask:0xf
v_mfma_f32_16x16x32_bf16 v[24:27], a[152:155], v[16:19], v[24:27]
v_add_f32_dpp v40, v30, v40 quad_perm:[2,2,2,2] row_mask:0xf bank_mask:0xf
v_mfma_f32_16x16x32_bf16 v[24:27], a[156:159], v[20:23], v[24:27]
v_add_f32_dpp v40, v31, v40 quad_perm:[3,3,3,3] row_mask:0xf bank_mask:0xf
v_cndmask_b32 v37, v37, v40, s[76:77]
v_mfma_f32_16x16x32_bf16 v[28:31], a[160:163], v[8:11], 0
v_mov_b32_dpp v40, v32 quad_perm:[0,0,0,0] row_mask:0xf bank_mask:0xf
s_mov_b32 s76, 286331153
s_mov_b32 s77, 286331153
v_mfma_f32_16x16x32_bf16 v[28:31], a[164:167], v[12:15], v[28:31]
v_add_f32_dpp v40, v33, v40 quad_perm:[1,1,1,1] row_mask:0xf bank_mask:0xf
v_mfma_f32_16x16x32_bf16 v[28:31], a[168:171], v[16:19], v[28:31]
v_add_f32_dpp v40, v34, v40 quad_perm:[2,2,2,2] row_mask:0xf bank_mask:0xf
v_mfma_f32_16x16x32_bf16 v[28:31], a[172:175], v[20:23], v[28:31]
v_add_f32_dpp v40, v35, v40 quad_perm:[3,3,3,3] row_mask:0xf bank_mask:0xf
v_cndmask_b32 v38, v38, v40, s[76:77]
v_mfma_f32_16x16x32_bf16 v[32:35], a[176:179], v[8:11], 0
v_mov_b32_dpp v40, v24 quad_perm:[0,0,0,0] row_mask:0xf bank_mask:0xf
s_mov_b32 s76, 572662306
s_mov_b32 s77, 572662306
v_mfma_f32_16x16x32_bf16 v[32:35], a[180:183], v[12:15], v[32:35]
v_add_f32_dpp v40, v25, v40 quad_perm:[1,1,1,1] row_mask:0xf bank_mask:0xf
v_mfma_f32_16x16x32_bf16 v[32:35], a[184:187], v[16:19], v[32:35]
v_add_f32_dpp v40, v26, v40 quad_perm:[2,2,2,2] row_mask:0xf bank_mask:0xf
v_mfma_f32_16x16x32_bf16 v[32:35], a[188:191], v[20:23], v[32:35]
v_add_f32_dpp v40, v27, v40 quad_perm:[3,3,3,3] row_mask:0xf bank_mask:0xf
v_cndmask_b32 v38, v38, v40, s[76:77]
v_mfma_f32_16x16x32_bf16 v[24:27], a[192:195], v[8:11], 0
v_mov_b32_dpp v40, v28 quad_perm:[0,0,0,0] row_mask:0xf bank_mask:0xf
s_mov_b32 s76, 1145324612
s_mov_b32 s77, 1145324612
v_mfma_f32_16x16x32_bf16 v[24:27], a[196:199], v[12:15], v[24:27]
v_add_f32_dpp v40, v29, v40 quad_perm:[1,1,1,1] row_mask:0xf bank_mask:0xf
v_mfma_f32_16x16x32_bf16 v[24:27], a[200:203], v[16:19], v[24:27]
v_add_f32_dpp v40, v30, v40 quad_perm:[2,2,2,2] row_mask:0xf bank_mask:0xf
v_mfma_f32_16x16x32_bf16 v[24:27], a[204:207], v[20:23], v[24:27]
v_add_f32_dpp v40, v31, v40 quad_perm:[3,3,3,3] row_mask:0xf bank_mask:0xf
v_cndmask_b32 v38, v38, v40, s[76:77]
v_mfma_f32_16x16x32_bf16 v[28:31], a[208:211], v[8:11], 0
v_mov_b32_dpp v40, v32 quad_perm:[0,0,0,0] row_mask:0xf bank_mask:0xf
s_mov_b32 s76, 2290649224
s_mov_b32 s77, 2290649224
v_mfma_f32_16x16x32_bf16 v[28:31], a[212:215], v[12:15], v[28:31]
v_add_f32_dpp v40, v33, v40 quad_perm:[1,1,1,1] row_mask:0xf bank_mask:0xf
v_mfma_f32_16x16x32_bf16 v[28:31], a[216:219], v[16:19], v[28:31]
v_add_f32_dpp v40, v34, v40 quad_perm:[2,2,2,2] row_mask:0xf bank_mask:0xf
v_mfma_f32_16x16x32_bf16 v[28:31], a[220:223], v[20:23], v[28:31]
v_add_f32_dpp v40, v35, v40 quad_perm:[3,3,3,3] row_mask:0xf bank_mask:0xf
v_cndmask_b32 v38, v38, v40, s[76:77]
v_mfma_f32_16x16x32_bf16 v[32:35], a[224:227], v[8:11], 0
v_mov_b32_dpp v40, v24 quad_perm:[0,0,0,0] row_mask:0xf bank_mask:0xf
s_mov_b32 s76, 286331153
s_mov_b32 s77, 286331153
v_mfma_f32_16x16x32_bf16 v[32:35], a[228:231], v[12:15], v[32:35]
v_add_f32_dpp v40, v25, v40 quad_perm:[1,1,1,1] row_mask:0xf bank_mask:0xf
v_mfma_f32_16x16x32_bf16 v[32:35], a[232:235], v[16:19], v[32:35]
v_add_f32_dpp v40, v26, v40 quad_perm:[2,2,2,2] row_mask:0xf bank_mask:0xf
v_mfma_f32_16x16x32_bf16 v[32:35], a[236:239], v[20:23], v[32:35]
v_add_f32_dpp v40, v27, v40 quad_perm:[3,3,3,3] row_mask:0xf bank_mask:0xf
v_cndmask_b32 v39, v39, v40, s[76:77]
v_mfma_f32_16x16x32_bf16 v[24:27], a[240:243], v[8:11], 0
v_mov_b32_dpp v40, v28 quad_perm:[0,0,0,0] row_mask:0xf bank_mask:0xf
s_mov_b32 s76, 572662306
s_mov_b32 s77, 572662306
v_mfma_f32_16x16x32_bf16 v[24:27], a[244:247], v[12:15], v[24:27]
v_add_f32_dpp v40, v29, v40 quad_perm:[1,1,1,1] row_mask:0xf bank_mask:0xf
v_mfma_f32_16x16x32_bf16 v[24:27], a[248:251], v[16:19], v[24:27]
v_add_f32_dpp v40, v30, v40 quad_perm:[2,2,2,2] row_mask:0xf bank_mask:0xf
v_mfma_f32_16x16x32_bf16 v[24:27], a[252:255], v[20:23], v[24:27]
v_add_f32_dpp v40, v31, v40 quad_perm:[3,3,3,3] row_mask:0xf bank_mask:0xf
v_cndmask_b32 v39, v39, v40, s[76:77]
v_mov_b32_dpp v40, v32 quad_perm:[0,0,0,0] row_mask:0xf bank_mask:0xf
s_mov_b32 s76, 1145324612
s_mov_b32 s77, 1145324612
v_add_f32_dpp v40, v33, v40 quad_perm:[1,1,1,1] row_mask:0xf bank_mask:0xf
v_add_f32_dpp v40, v34, v40 quad_perm:[2,2,2,2] row_mask:0xf bank_mask:0xf
v_add_f32_dpp v40, v35, v40 quad_perm:[3,3,3,3] row_mask:0xf bank_mask:0xf
v_cndmask_b32 v39, v39, v40, s[76:77]
v_mov_b32_dpp v40, v24 quad_perm:[0,0,0,0] row_mask:0xf bank_mask:0xf
s_mov_b32 s76, 2290649224
s_mov_b32 s77, 2290649224
v_add_f32_dpp v40, v25, v40 quad_perm:[1,1,1,1] row_mask:0xf bank_mask:0xf
v_add_f32_dpp v40, v26, v40 quad_perm:[2,2,2,2] row_mask:0xf bank_mask:0xf
v_add_f32_dpp v40, v27, v40 quad_perm:[3,3,3,3] row_mask:0xf bank_mask:0xf
v_cndmask_b32 v39, v39, v40, s[76:77]
v_max3_f32 v40, v36, v37, v38
v_max_f32 v40, v40, v39
s_nop 1
v_max_f32_dpp v40, v40, v40 quad_perm:[1,0,3,2] row_mask:0xf bank_mask:0xf
s_nop 1
v_max_f32_dpp v40, v40, v40 quad_perm:[2,3,0,1] row_mask:0xf bank_mask:0xf
s_nop 1
v_max_f32_dpp v40, v40, v40 row_half_mirror row_mask:0xf bank_mask:0xf
s_nop 1
v_max_f32_dpp v40, v40, v40 row_mirror row_mask:0xf bank_mask:0xf
v_mov_b32 v41, v40
s_nop 1
v_permlane16_swap_b32 v40, v41
v_max_f32 v40, v40, v41
v_mov_b32 v41, v40
s_nop 1
v_permlane32_swap_b32 v40, v41
v_max_f32 v40, v40, v41
v_mul_f32 v40, s82, v40
v_fma_f32 v36, v36, s82, -v40
v_fma_f32 v37, v37, s82, -v40
v_fma_f32 v38, v38, s82, -v40
v_fma_f32 v39, v39, s82, -v40
v_exp_f32 v36, v36
v_exp_f32 v37, v37
v_exp_f32 v38, v38
v_exp_f32 v39, v39
v_cvt_pk_bf16_f32 v42, v36, v37
v_cvt_pk_bf16_f32 v43, v38, v39
ds_write_b64 v45, v[42:43]
v_add_f32 v41, v36, v37
v_add_f32 v42, v38, v39
v_add_f32 v41, v41, v42
s_nop 1
v_add_f32_dpp v41, v41, v41 quad_perm:[1,0,3,2] row_mask:0xf bank_mask:0xf
s_nop 1
v_add_f32_dpp v41, v41, v41 quad_perm:[2,3,0,1] row_mask:0xf bank_mask:0xf
s_nop 1
v_add_f32_dpp v41, v41, v41 row_half_mirror row_mask:0xf bank_mask:0xf
s_nop 1
v_add_f32_dpp v41, v41, v41 row_mirror row_mask:0xf bank_mask:0xf
v_mov_b32 v42, v41
s_nop 1
v_permlane16_swap_b32 v41, v42
v_add_f32 v41, v41, v42
v_mov_b32 v42, v41
s_nop 1
v_permlane32_swap_b32 v41, v42
v_add_f32 v41, v41, v42
s_lshl_b32 s3, s62, 3
v_mov_b32 v42, s3
ds_write_b64 v42, v[40:41] offset:29184
v_bfe_u32 v47, v0, 4, 6
v_lshlrev_b32 v47, 4, v47
s_lshl_b32 s3, s62, 14
s_add_u32 s3, s3, 32768
v_add_u32 v47, s3, v47
s_waitcnt vmcnt(40)
v_perm_b32 v44, v68, v64, s84
v_perm_b32 v68, v68, v64, s85
v_mov_b32 v64, v44
v_perm_b32 v44, v76, v72, s84
v_perm_b32 v45, v76, v72, s85
v_perm_b32 v72, v69, v65, s84
v_perm_b32 v76, v69, v65, s85
v_mov_b32 v65, v44
v_mov_b32 v69, v45
v_perm_b32 v44, v84, v80, s84
v_perm_b32 v45, v84, v80, s85
v_perm_b32 v80, v70, v66, s84
v_perm_b32 v84, v70, v66, s85
v_mov_b32 v66, v44
v_mov_b32 v70, v45
v_perm_b32 v44, v92, v88, s84
v_perm_b32 v45, v92, v88, s85
v_perm_b32 v88, v71, v67, s84
v_perm_b32 v92, v71, v67, s85
v_mov_b32 v67, v44
v_mov_b32 v71, v45
v_perm_b32 v44, v77, v73, s84
v_perm_b32 v77, v77, v73, s85
v_mov_b32 v73, v44
v_perm_b32 v44, v85, v81, s84
v_perm_b32 v45, v85, v81, s85
v_perm_b32 v81, v78, v74, s84
v_perm_b32 v85, v78, v74, s85
v_mov_b32 v74, v44
v_mov_b32 v78, v45
v_perm_b32 v44, v93, v89, s84
v_perm_b32 v45, v93, v89, s85
v_perm_b32 v89, v79, v75, s84
v_perm_b32 v93, v79, v75, s85
v_mov_b32 v75, v44
v_mov_b32 v79, v45
v_perm_b32 v44, v86, v82, s84
v_perm_b32 v86, v86, v82, s85
v_mov_b32 v82, v44
v_perm_b32 v44, v94, v90, s84
v_perm_b32 v45, v94, v90, s85
v_perm_b32 v90, v87, v83, s84
v_perm_b32 v94, v87, v83, s85
v_mov_b32 v83, v44
v_mov_b32 v87, v45
v_perm_b32 v44, v95, v91, s84
v_perm_b32 v95, v95, v91, s85
v_mov_b32 v91, v44
ds_read_b128 v[40:43], v46 offset:0
s_waitcnt lgkmcnt(0)
v_mfma_f32_16x16x32_bf16 v[8:11], v[40:43], v[64:67], 0
v_mfma_f32_16x16x32_bf16 v[12:15], v[40:43], v[68:71], 0
v_mfma_f32_16x16x32_bf16 v[16:19], v[40:43], v[72:75], 0
v_mfma_f32_16x16x32_bf16 v[20:23], v[40:43], v[76:79], 0
v_mfma_f32_16x16x32_bf16 v[24:27], v[40:43], v[80:83], 0
v_mfma_f32_16x16x32_bf16 v[28:31], v[40:43], v[84:87], 0
v_mfma_f32_16x16x32_bf16 v[32:35], v[40:43], v[88:91], 0
v_mfma_f32_16x16x32_bf16 v[36:39], v[40:43], v[92:95], 0
ds_write_b128 v47, v[64:67] offset:0
ds_write_b128 v47, v[68:71] offset:1024
ds_write_b128 v47, v[72:75] offset:2048
ds_write_b128 v47, v[76:79] offset:3072
ds_write_b128 v47, v[80:83] offset:4096
ds_write_b128 v47, v[84:87] offset:5120
ds_write_b128 v47, v[88:91] offset:6144
ds_write_b128 v47, v[92:95] offset:7168
s_waitcnt lgkmcnt(0)
s_mov_b32 s5, 49152
buffer_load_dwordx4 v[64:67], v63, s[12:15], s5 offen offset:0 nt
buffer_load_dwordx4 v[68:71], v63, s[12:15], s5 offen offset:256 nt
buffer_load_dwordx4 v[72:75], v63, s[12:15], s5 offen offset:512 nt
buffer_load_dwordx4 v[76:79], v63, s[12:15], s5 offen offset:768 nt
buffer_load_dwordx4 v[80:83], v63, s[12:15], s5 offen offset:1024 nt
buffer_load_dwordx4 v[84:87], v63, s[12:15], s5 offen offset:1280 nt
buffer_load_dwordx4 v[88:91], v63, s[12:15], s5 offen offset:1536 nt
buffer_load_dwordx4 v[92:95], v63, s[12:15], s5 offen offset:1792 nt
s_waitcnt vmcnt(40)
v_perm_b32 v44, v100, v96, s84
v_perm_b32 v100, v100, v96, s85
v_mov_b32 v96, v44
v_perm_b32 v44, v108, v104, s84
v_perm_b32 v45, v108, v104, s85
v_perm_b32 v104, v101, v97, s84
v_perm_b32 v108, v101, v97, s85
v_mov_b32 v97, v44
v_mov_b32 v101, v45
v_perm_b32 v44, v116, v112, s84
v_perm_b32 v45, v116, v112, s85
v_perm_b32 v112, v102, v98, s84
v_perm_b32 v116, v102, v98, s85
v_mov_b32 v98, v44
v_mov_b32 v102, v45
v_perm_b32 v44, v124, v120, s84
v_perm_b32 v45, v124, v120, s85
v_perm_b32 v120, v103, v99, s84
v_perm_b32 v124, v103, v99, s85
v_mov_b32 v99, v44
v_mov_b32 v103, v45
v_perm_b32 v44, v109, v105, s84
v_perm_b32 v109, v109, v105, s85
v_mov_b32 v105, v44
v_perm_b32 v44, v117, v113, s84
v_perm_b32 v45, v117, v113, s85
v_perm_b32 v113, v110, v106, s84
v_perm_b32 v117, v110, v106, s85
v_mov_b32 v106, v44
v_mov_b32 v110, v45
v_perm_b32 v44, v125, v121, s84
v_perm_b32 v45, v125, v121, s85
v_perm_b32 v121, v111, v107, s84
v_perm_b32 v125, v111, v107, s85
v_mov_b32 v107, v44
v_mov_b32 v111, v45
v_perm_b32 v44, v118, v114, s84
v_perm_b32 v118, v118, v114, s85
v_mov_b32 v114, v44
v_perm_b32 v44, v126, v122, s84
v_perm_b32 v45, v126, v122, s85
v_perm_b32 v122, v119, v115, s84
v_perm_b32 v126, v119, v115, s85
v_mov_b32 v115, v44
v_mov_b32 v119, v45
v_perm_b32 v44, v127, v123, s84
v_perm_b32 v127, v127, v123, s85
v_mov_b32 v123, v44
ds_read_b128 v[40:43], v46 offset:64
s_waitcnt lgkmcnt(0)
v_mfma_f32_16x16x32_bf16 v[8:11], v[40:43], v[96:99], v[8:11]
v_mfma_f32_16x16x32_bf16 v[12:15], v[40:43], v[100:103], v[12:15]
v_mfma_f32_16x16x32_bf16 v[16:19], v[40:43], v[104:107], v[16:19]
v_mfma_f32_16x16x32_bf16 v[20:23], v[40:43], v[108:111], v[20:23]
v_mfma_f32_16x16x32_bf16 v[24:27], v[40:43], v[112:115], v[24:27]
v_mfma_f32_16x16x32_bf16 v[28:31], v[40:43], v[116:119], v[28:31]
v_mfma_f32_16x16x32_bf16 v[32:35], v[40:43], v[120:123], v[32:35]
v_mfma_f32_16x16x32_bf16 v[36:39], v[40:43], v[124:127], v[36:39]
ds_write_b128 v47, v[96:99] offset:8192
ds_write_b128 v47, v[100:103] offset:9216
ds_write_b128 v47, v[104:107] offset:10240
ds_write_b128 v47, v[108:111] offset:11264
ds_write_b128 v47, v[112:115] offset:12288
ds_write_b128 v47, v[116:119] offset:13312
ds_write_b128 v47, v[120:123] offset:14336
ds_write_b128 v47, v[124:127] offset:15360
s_waitcnt lgkmcnt(0)
s_waitcnt vmcnt(32)
v_perm_b32 v44, v132, v128, s84
v_perm_b32 v132, v132, v128, s85
v_mov_b32 v128, v44
v_perm_b32 v44, v140, v136, s84
v_perm_b32 v45, v140, v136, s85
v_perm_b32 v136, v133, v129, s84
v_perm_b32 v140, v133, v129, s85
v_mov_b32 v129, v44
v_mov_b32 v133, v45
v_perm_b32 v44, v148, v144, s84
v_perm_b32 v45, v148, v144, s85
v_perm_b32 v144, v134, v130, s84
v_perm_b32 v148, v134, v130, s85
v_mov_b32 v130, v44
v_mov_b32 v134, v45
v_perm_b32 v44, v156, v152, s84
v_perm_b32 v45, v156, v152, s85
v_perm_b32 v152, v135, v131, s84
v_perm_b32 v156, v135, v131, s85
v_mov_b32 v131, v44
v_mov_b32 v135, v45
v_perm_b32 v44, v141, v137, s84
v_perm_b32 v141, v141, v137, s85
v_mov_b32 v137, v44
v_perm_b32 v44, v149, v145, s84
v_perm_b32 v45, v149, v145, s85
v_perm_b32 v145, v142, v138, s84
v_perm_b32 v149, v142, v138, s85
v_mov_b32 v138, v44
v_mov_b32 v142, v45
v_perm_b32 v44, v157, v153, s84
v_perm_b32 v45, v157, v153, s85
v_perm_b32 v153, v143, v139, s84
v_perm_b32 v157, v143, v139, s85
v_mov_b32 v139, v44
v_mov_b32 v143, v45
v_perm_b32 v44, v150, v146, s84
v_perm_b32 v150, v150, v146, s85
v_mov_b32 v146, v44
v_perm_b32 v44, v158, v154, s84
v_perm_b32 v45, v158, v154, s85
v_perm_b32 v154, v151, v147, s84
v_perm_b32 v158, v151, v147, s85
v_mov_b32 v147, v44
v_mov_b32 v151, v45
v_perm_b32 v44, v159, v155, s84
v_perm_b32 v159, v159, v155, s85
v_mov_b32 v155, v44
ds_read_b128 v[40:43], v46 offset:128
s_waitcnt lgkmcnt(0)
v_mfma_f32_16x16x32_bf16 v[8:11], v[40:43], v[128:131], v[8:11]
v_mfma_f32_16x16x32_bf16 v[12:15], v[40:43], v[132:135], v[12:15]
v_mfma_f32_16x16x32_bf16 v[16:19], v[40:43], v[136:139], v[16:19]
v_mfma_f32_16x16x32_bf16 v[20:23], v[40:43], v[140:143], v[20:23]
v_mfma_f32_16x16x32_bf16 v[24:27], v[40:43], v[144:147], v[24:27]
v_mfma_f32_16x16x32_bf16 v[28:31], v[40:43], v[148:151], v[28:31]
v_mfma_f32_16x16x32_bf16 v[32:35], v[40:43], v[152:155], v[32:35]
v_mfma_f32_16x16x32_bf16 v[36:39], v[40:43], v[156:159], v[36:39]
v_mov_b32 v45, v63
v_bfe_u32 v44, v0, 4, 4
v_lshlrev_b32 v44, 3, v44
v_bfe_u32 v47, v0, 8, 4
v_lshl_add_u32 v44, v47, 13, v44
buffer_load_dwordx2 v[48:49], v44, s[24:27], 0 offen offset:0
buffer_load_dwordx2 v[50:51], v44, s[24:27], 0 offen offset:1024
buffer_load_dwordx2 v[52:53], v44, s[24:27], 0 offen offset:2048
buffer_load_dwordx2 v[54:55], v44, s[24:27], 0 offen offset:3072
buffer_load_dwordx2 v[56:57], v44, s[24:27], s90 offen offset:0
buffer_load_dwordx2 v[58:59], v44, s[24:27], s90 offen offset:1024
buffer_load_dwordx2 v[60:61], v44, s[24:27], s90 offen offset:2048
buffer_load_dwordx2 v[62:63], v44, s[24:27], s90 offen offset:3072
v_and_b32 v44, 0xf0, v0
buffer_load_dword v47, v44, s[56:59], 0 offen sc1
s_mov_b32 s5, 57344
buffer_load_dwordx4 v[96:99], v45, s[12:15], s5 offen offset:0 nt
buffer_load_dwordx4 v[100:103], v45, s[12:15], s5 offen offset:256 nt
buffer_load_dwordx4 v[104:107], v45, s[12:15], s5 offen offset:512 nt
buffer_load_dwordx4 v[108:111], v45, s[12:15], s5 offen offset:768 nt
buffer_load_dwordx4 v[112:115], v45, s[12:15], s5 offen offset:1024 nt
buffer_load_dwordx4 v[116:119], v45, s[12:15], s5 offen offset:1280 nt
buffer_load_dwordx4 v[120:123], v45, s[12:15], s5 offen offset:1536 nt
buffer_load_dwordx4 v[124:127], v45, s[12:15], s5 offen offset:1792 nt
s_waitcnt vmcnt(41)
v_perm_b32 v44, v164, v160, s84
v_perm_b32 v164, v164, v160, s85
v_mov_b32 v160, v44
v_perm_b32 v44, v172, v168, s84
v_perm_b32 v45, v172, v168, s85
v_perm_b32 v168, v165, v161, s84
v_perm_b32 v172, v165, v161, s85
v_mov_b32 v161, v44
v_mov_b32 v165, v45
v_perm_b32 v44, v180, v176, s84
v_perm_b32 v45, v180, v176, s85
v_perm_b32 v176, v166, v162, s84
v_perm_b32 v180, v166, v162, s85
v_mov_b32 v162, v44
v_mov_b32 v166, v45
v_perm_b32 v44, v188, v184, s84
v_perm_b32 v45, v188, v184, s85
v_perm_b32 v184, v167, v163, s84
v_perm_b32 v188, v167, v163, s85
v_mov_b32 v163, v44
v_mov_b32 v167, v45
v_perm_b32 v44, v173, v169, s84
v_perm_b32 v173, v173, v169, s85
v_mov_b32 v169, v44
v_perm_b32 v44, v181, v177, s84
v_perm_b32 v45, v181, v177, s85
v_perm_b32 v177, v174, v170, s84
v_perm_b32 v181, v174, v170, s85
v_mov_b32 v170, v44
v_mov_b32 v174, v45
v_perm_b32 v44, v189, v185, s84
v_perm_b32 v45, v189, v185, s85
v_perm_b32 v185, v175, v171, s84
v_perm_b32 v189, v175, v171, s85
v_mov_b32 v171, v44
v_mov_b32 v175, v45
v_perm_b32 v44, v182, v178, s84
v_perm_b32 v182, v182, v178, s85
v_mov_b32 v178, v44
v_perm_b32 v44, v190, v186, s84
v_perm_b32 v45, v190, v186, s85
v_perm_b32 v186, v183, v179, s84
v_perm_b32 v190, v183, v179, s85
v_mov_b32 v179, v44
v_mov_b32 v183, v45
v_perm_b32 v44, v191, v187, s84
v_perm_b32 v191, v191, v187, s85
v_mov_b32 v187, v44
ds_read_b128 v[40:43], v46 offset:192
s_waitcnt lgkmcnt(0)
v_mfma_f32_16x16x32_bf16 v[8:11], v[40:43], v[160:163], v[8:11]
v_mfma_f32_16x16x32_bf16 v[12:15], v[40:43], v[164:167], v[12:15]
v_mfma_f32_16x16x32_bf16 v[16:19], v[40:43], v[168:171], v[16:19]
v_mfma_f32_16x16x32_bf16 v[20:23], v[40:43], v[172:175], v[20:23]
v_mfma_f32_16x16x32_bf16 v[24:27], v[40:43], v[176:179], v[24:27]
v_mfma_f32_16x16x32_bf16 v[28:31], v[40:43], v[180:183], v[28:31]
v_mfma_f32_16x16x32_bf16 v[32:35], v[40:43], v[184:187], v[32:35]
v_mfma_f32_16x16x32_bf16 v[36:39], v[40:43], v[188:191], v[36:39]
s_waitcnt vmcnt(33)
v_perm_b32 v44, v196, v192, s84
v_perm_b32 v196, v196, v192, s85
v_mov_b32 v192, v44
v_perm_b32 v44, v204, v200, s84
v_perm_b32 v45, v204, v200, s85
v_perm_b32 v200, v197, v193, s84
v_perm_b32 v204, v197, v193, s85
v_mov_b32 v193, v44
v_mov_b32 v197, v45
v_perm_b32 v44, v212, v208, s84
v_perm_b32 v45, v212, v208, s85
v_perm_b32 v208, v198, v194, s84
v_perm_b32 v212, v198, v194, s85
v_mov_b32 v194, v44
v_mov_b32 v198, v45
v_perm_b32 v44, v220, v216, s84
v_perm_b32 v45, v220, v216, s85
v_perm_b32 v216, v199, v195, s84
v_perm_b32 v220, v199, v195, s85
v_mov_b32 v195, v44
v_mov_b32 v199, v45
v_perm_b32 v44, v205, v201, s84
v_perm_b32 v205, v205, v201, s85
v_mov_b32 v201, v44
v_perm_b32 v44, v213, v209, s84
v_perm_b32 v45, v213, v209, s85
v_perm_b32 v209, v206, v202, s84
v_perm_b32 v213, v206, v202, s85
v_mov_b32 v202, v44
v_mov_b32 v206, v45
v_perm_b32 v44, v221, v217, s84
v_perm_b32 v45, v221, v217, s85
v_perm_b32 v217, v207, v203, s84
v_perm_b32 v221, v207, v203, s85
v_mov_b32 v203, v44
v_mov_b32 v207, v45
v_perm_b32 v44, v214, v210, s84
v_perm_b32 v214, v214, v210, s85
v_mov_b32 v210, v44
v_perm_b32 v44, v222, v218, s84
v_perm_b32 v45, v222, v218, s85
v_perm_b32 v218, v215, v211, s84
v_perm_b32 v222, v215, v211, s85
v_mov_b32 v211, v44
v_mov_b32 v215, v45
v_perm_b32 v44, v223, v219, s84
v_perm_b32 v223, v223, v219, s85
v_mov_b32 v219, v44
ds_read_b128 v[40:43], v46 offset:256
s_waitcnt lgkmcnt(0)
v_mfma_f32_16x16x32_bf16 v[8:11], v[40:43], v[192:195], v[8:11]
v_mfma_f32_16x16x32_bf16 v[12:15], v[40:43], v[196:199], v[12:15]
v_mfma_f32_16x16x32_bf16 v[16:19], v[40:43], v[200:203], v[16:19]
v_mfma_f32_16x16x32_bf16 v[20:23], v[40:43], v[204:207], v[20:23]
v_mfma_f32_16x16x32_bf16 v[24:27], v[40:43], v[208:211], v[24:27]
v_mfma_f32_16x16x32_bf16 v[28:31], v[40:43], v[212:215], v[28:31]
v_mfma_f32_16x16x32_bf16 v[32:35], v[40:43], v[216:219], v[32:35]
v_mfma_f32_16x16x32_bf16 v[36:39], v[40:43], v[220:223], v[36:39]
s_waitcnt vmcnt(25)
v_perm_b32 v44, v228, v224, s84
v_perm_b32 v228, v228, v224, s85
v_mov_b32 v224, v44
v_perm_b32 v44, v236, v232, s84
v_perm_b32 v45, v236, v232, s85
v_perm_b32 v232, v229, v225, s84
v_perm_b32 v236, v229, v225, s85
v_mov_b32 v225, v44
v_mov_b32 v229, v45
v_perm_b32 v44, v244, v240, s84
v_perm_b32 v45, v244, v240, s85
v_perm_b32 v240, v230, v226, s84
v_perm_b32 v244, v230, v226, s85
v_mov_b32 v226, v44
v_mov_b32 v230, v45
v_perm_b32 v44, v252, v248, s84
v_perm_b32 v45, v252, v248, s85
v_perm_b32 v248, v231, v227, s84
v_perm_b32 v252, v231, v227, s85
v_mov_b32 v227, v44
v_mov_b32 v231, v45
v_perm_b32 v44, v237, v233, s84
v_perm_b32 v237, v237, v233, s85
v_mov_b32 v233, v44
v_perm_b32 v44, v245, v241, s84
v_perm_b32 v45, v245, v241, s85
v_perm_b32 v241, v238, v234, s84
v_perm_b32 v245, v238, v234, s85
v_mov_b32 v234, v44
v_mov_b32 v238, v45
v_perm_b32 v44, v253, v249, s84
v_perm_b32 v45, v253, v249, s85
v_perm_b32 v249, v239, v235, s84
v_perm_b32 v253, v239, v235, s85
v_mov_b32 v235, v44
v_mov_b32 v239, v45
v_perm_b32 v44, v246, v242, s84
v_perm_b32 v246, v246, v242, s85
v_mov_b32 v242, v44
v_perm_b32 v44, v254, v250, s84
v_perm_b32 v45, v254, v250, s85
v_perm_b32 v250, v247, v243, s84
v_perm_b32 v254, v247, v243, s85
v_mov_b32 v243, v44
v_mov_b32 v247, v45
v_perm_b32 v44, v255, v251, s84
v_perm_b32 v255, v255, v251, s85
v_mov_b32 v251, v44
ds_read_b128 v[40:43], v46 offset:320
s_waitcnt lgkmcnt(0)
v_mfma_f32_16x16x32_bf16 v[8:11], v[40:43], v[224:227], v[8:11]
v_mfma_f32_16x16x32_bf16 v[12:15], v[40:43], v[228:231], v[12:15]
v_mfma_f32_16x16x32_bf16 v[16:19], v[40:43], v[232:235], v[16:19]
v_mfma_f32_16x16x32_bf16 v[20:23], v[40:43], v[236:239], v[20:23]
v_mfma_f32_16x16x32_bf16 v[24:27], v[40:43], v[240:243], v[24:27]
v_mfma_f32_16x16x32_bf16 v[28:31], v[40:43], v[244:247], v[28:31]
v_mfma_f32_16x16x32_bf16 v[32:35], v[40:43], v[248:251], v[32:35]
v_mfma_f32_16x16x32_bf16 v[36:39], v[40:43], v[252:255], v[36:39]
s_waitcnt vmcnt(17)
v_perm_b32 v44, v68, v64, s84
v_perm_b32 v68, v68, v64, s85
v_mov_b32 v64, v44
v_perm_b32 v44, v76, v72, s84
v_perm_b32 v45, v76, v72, s85
v_perm_b32 v72, v69, v65, s84
v_perm_b32 v76, v69, v65, s85
v_mov_b32 v65, v44
v_mov_b32 v69, v45
v_perm_b32 v44, v84, v80, s84
v_perm_b32 v45, v84, v80, s85
v_perm_b32 v80, v70, v66, s84
v_perm_b32 v84, v70, v66, s85
v_mov_b32 v66, v44
v_mov_b32 v70, v45
v_perm_b32 v44, v92, v88, s84
v_perm_b32 v45, v92, v88, s85
v_perm_b32 v88, v71, v67, s84
v_perm_b32 v92, v71, v67, s85
v_mov_b32 v67, v44
v_mov_b32 v71, v45
v_perm_b32 v44, v77, v73, s84
v_perm_b32 v77, v77, v73, s85
v_mov_b32 v73, v44
v_perm_b32 v44, v85, v81, s84
v_perm_b32 v45, v85, v81, s85
v_perm_b32 v81, v78, v74, s84
v_perm_b32 v85, v78, v74, s85
v_mov_b32 v74, v44
v_mov_b32 v78, v45
v_perm_b32 v44, v93, v89, s84
v_perm_b32 v45, v93, v89, s85
v_perm_b32 v89, v79, v75, s84
v_perm_b32 v93, v79, v75, s85
v_mov_b32 v75, v44
v_mov_b32 v79, v45
v_perm_b32 v44, v86, v82, s84
v_perm_b32 v86, v86, v82, s85
v_mov_b32 v82, v44
v_perm_b32 v44, v94, v90, s84
v_perm_b32 v45, v94, v90, s85
v_perm_b32 v90, v87, v83, s84
v_perm_b32 v94, v87, v83, s85
v_mov_b32 v83, v44
v_mov_b32 v87, v45
v_perm_b32 v44, v95, v91, s84
v_perm_b32 v95, v95, v91, s85
v_mov_b32 v91, v44
ds_read_b128 v[40:43], v46 offset:384
s_waitcnt lgkmcnt(0)
v_mfma_f32_16x16x32_bf16 v[8:11], v[40:43], v[64:67], v[8:11]
v_mfma_f32_16x16x32_bf16 v[12:15], v[40:43], v[68:71], v[12:15]
v_mfma_f32_16x16x32_bf16 v[16:19], v[40:43], v[72:75], v[16:19]
v_mfma_f32_16x16x32_bf16 v[20:23], v[40:43], v[76:79], v[20:23]
v_mfma_f32_16x16x32_bf16 v[24:27], v[40:43], v[80:83], v[24:27]
v_mfma_f32_16x16x32_bf16 v[28:31], v[40:43], v[84:87], v[28:31]
v_mfma_f32_16x16x32_bf16 v[32:35], v[40:43], v[88:91], v[32:35]
v_mfma_f32_16x16x32_bf16 v[36:39], v[40:43], v[92:95], v[36:39]
s_waitcnt vmcnt(0)
s_mov_b32 s80, 0
C_2:
v_cmp_gt_u32 vcc, 16, v47
s_nop 0
s_cbranch_vccz CD_3
s_add_u32 s80, s80, 1
s_cmp_gt_u32 s80, 100000
s_cbranch_scc1 CD_3
v_and_b32 v44, 0xf0, v0
buffer_load_dword v47, v44, s[56:59], 0 offen sc1
s_waitcnt vmcnt(0)
s_branch C_2
CD_3:
v_perm_b32 v44, v100, v96, s84
v_perm_b32 v100, v100, v96, s85
v_mov_b32 v96, v44
v_perm_b32 v44, v108, v104, s84
v_perm_b32 v45, v108, v104, s85
v_perm_b32 v104, v101, v97, s84
v_perm_b32 v108, v101, v97, s85
v_mov_b32 v97, v44
v_mov_b32 v101, v45
v_perm_b32 v44, v116, v112, s84
v_perm_b32 v45, v116, v112, s85
v_perm_b32 v112, v102, v98, s84
v_perm_b32 v116, v102, v98, s85
v_mov_b32 v98, v44
v_mov_b32 v102, v45
v_perm_b32 v44, v124, v120, s84
v_perm_b32 v45, v124, v120, s85
v_perm_b32 v120, v103, v99, s84
v_perm_b32 v124, v103, v99, s85
v_mov_b32 v99, v44
v_mov_b32 v103, v45
v_perm_b32 v44, v109, v105, s84
v_perm_b32 v109, v109, v105, s85
v_mov_b32 v105, v44
v_perm_b32 v44, v117, v113, s84
v_perm_b32 v45, v117, v113, s85
v_perm_b32 v113, v110, v106, s84
v_perm_b32 v117, v110, v106, s85
v_mov_b32 v106, v44
v_mov_b32 v110, v45
v_perm_b32 v44, v125, v121, s84
v_perm_b32 v45, v125, v121, s85
v_perm_b32 v121, v111, v107, s84
v_perm_b32 v125, v111, v107, s85
v_mov_b32 v107, v44
v_mov_b32 v111, v45
v_perm_b32 v44, v118, v114, s84
v_perm_b32 v118, v118, v114, s85
v_mov_b32 v114, v44
v_perm_b32 v44, v126, v122, s84
v_perm_b32 v45, v126, v122, s85
v_perm_b32 v122, v119, v115, s84
v_perm_b32 v126, v119, v115, s85
v_mov_b32 v115, v44
v_mov_b32 v119, v45
v_perm_b32 v44, v127, v123, s84
v_perm_b32 v127, v127, v123, s85
v_mov_b32 v123, v44
ds_read_b128 v[40:43], v46 offset:448
s_waitcnt lgkmcnt(0)
v_mfma_f32_16x16x32_bf16 v[8:11], v[40:43], v[96:99], v[8:11]
v_mfma_f32_16x16x32_bf16 v[12:15], v[40:43], v[100:103], v[12:15]
v_mfma_f32_16x16x32_bf16 v[16:19], v[40:43], v[104:107], v[16:19]
v_mfma_f32_16x16x32_bf16 v[20:23], v[40:43], v[108:111], v[20:23]
v_mfma_f32_16x16x32_bf16 v[24:27], v[40:43], v[112:115], v[24:27]
v_mfma_f32_16x16x32_bf16 v[28:31], v[40:43], v[116:119], v[28:31]
v_mfma_f32_16x16x32_bf16 v[32:35], v[40:43], v[120:123], v[32:35]
v_mfma_f32_16x16x32_bf16 v[36:39], v[40:43], v[124:127], v[36:39]
s_lshl_b32 s3, s61, 19
s_add_u32 s20, s20, s3
s_addc_u32 s21, s21, 0
s_sub_u32 s22, s22, s3
s_add_u32 s8, s16, 12582912
s_addc_u32 s9, s17, 0
s_mov_b32 s10, 4194304
s_mov_b32 s11, 0x20000
v_bfe_u32 v45, v0, 4, 4
v_lshlrev_b32 v45, 5, v45
v_bfe_u32 v47, v0, 10, 2
v_lshl_add_u32 v45, v47, 9, v45
v_add_u32 v45, 0, v45
v_mov_b32 v9, v12
v_mov_b32 v10, v16
v_mov_b32 v11, v20
v_mov_b32 v25, v28
v_mov_b32 v26, v32
v_mov_b32 v27, v36
s_mov_b64 exec, 0xffff
ds_write_b128 v45, v[8:11]
ds_write_b128 v45, v[24:27] offset:16
s_mov_b64 exec, -1
s_waitcnt lgkmcnt(0)
s_barrier
s_cmp_lg_u32 s62, 0
s_cbranch_scc1 S_4
v_mov_b32 v44, 29184
ds_read_b128 v[24:27], v44
ds_read_b128 v[28:31], v44 offset:16
ds_read_b128 v[8:11], v0 offset:0
ds_read_b128 v[12:15], v0 offset:512
ds_read_b128 v[16:19], v0 offset:1024
ds_read_b128 v[20:23], v0 offset:1536
s_mul_i32 s81, s60, 4224
s_lshl_b32 s3, s61, 4
s_add_u32 s81, s81, s3
s_add_u32 s81, s81, 0
v_lshlrev_b32 v44, 3, v0
s_mov_b32 s76, 0
s_mov_b32 s77, -1
s_waitcnt lgkmcnt(4)
v_max3_f32 v32, v24, v26, v28
v_max_f32 v32, v32, v30
v_sub_f32 v24, v24, v32
v_sub_f32 v26, v26, v32
v_sub_f32 v28, v28, v32
v_sub_f32 v30, v30, v32
v_exp_f32 v24, v24
v_exp_f32 v26, v26
v_exp_f32 v28, v28
v_exp_f32 v30, v30
v_mul_f32 v33, v24, v25
v_fmac_f32 v33, v26, v27
v_fmac_f32 v33, v28, v29
v_fmac_f32 v33, v30, v31
s_waitcnt lgkmcnt(0)
v_mul_f32 v8, v24, v8
v_mul_f32 v9, v24, v9
v_mul_f32 v10, v24, v10
v_mul_f32 v11, v24, v11
v_fmac_f32 v8, v26, v12
v_fmac_f32 v9, v26, v13
v_fmac_f32 v10, v26, v14
v_fmac_f32 v11, v26, v15
v_fmac_f32 v8, v28, v16
v_fmac_f32 v9, v28, v17
v_fmac_f32 v10, v28, v18
v_fmac_f32 v11, v28, v19
v_fmac_f32 v8, v30, v20
v_fmac_f32 v9, v30, v21
v_fmac_f32 v10, v30, v22
v_fmac_f32 v11, v30, v23
v_cndmask_b32 v8, v8, v32, s[76:77]
v_cndmask_b32 v9, v9, v33, s[76:77]
s_mov_b32 exec_hi, 1
buffer_store_dwordx4 v[8:11], v44, s[8:11], s81 offen
buffer_store_dwordx4 v[8:11], v44, s[16:19], s81 offen sc1
s_mov_b64 exec, -1
S_4:
v_bfe_u32 v41, v0, 4, 3
v_lshlrev_b32 v41, 4, v41
v_add_u32 v41, 4096, v41
s_mov_b32 s81, 0
s_bfe_u32 s3, s60, 327680
s_mul_i32 s3, s3, 4224
s_add_u32 s81, s81, s3
v_bfe_u32 v44, v0, 4, 2
v_lshlrev_b32 v44, 8, v44
v_bfe_u32 v47, v0, 6, 2
v_lshl_add_u32 v44, v47, 12, v44
v_bfe_u32 v47, v0, 8, 1
v_lshl_add_u32 v44, v47, 7, v44
s_mov_b32 s4, 270336
s_bfe_u32 s3, s61, 196608
s_mul_i32 s3, s3, 16384
s_add_u32 s4, s4, s3
s_bfe_u32 s3, s60, 131072
s_mul_i32 s3, s3, 1024
s_add_u32 s4, s4, s3
s_bfe_u32 s3, s60, 196610
s_mul_i32 s3, s3, 16
s_add_u32 s4, s4, s3
v_bfe_u32 v46, v0, 4, 4
v_lshlrev_b32 v46, 4, v46
v_bfe_u32 v47, v0, 8, 4
v_lshl_add_u32 v46, v47, 15, v46
s_barrier
v_bfe_u32 v36, v0, 4, 3
v_lshlrev_b32 v36, 4, v36
v_bfe_u32 v47, v0, 7, 5
v_lshl_add_u32 v36, v47, 15, v36
s_lshl_b32 s3, s93, 7
s_add_u32 s3, s3, 4194304
v_mov_b32 v32, -1
v_mov_b32 v33, -1
v_mov_b32 v34, -1
v_mov_b32 v35, -1
buffer_store_dwordx4 v[32:35], v36, s[16:19], s3 offen sc1
s_add_u32 s3, s3, 1048576
buffer_store_dwordx4 v[32:35], v36, s[16:19], s3 offen sc1
s_add_u32 s3, s3, 1048576
buffer_store_dwordx4 v[32:35], v36, s[16:19], s3 offen sc1
s_add_u32 s3, s3, 1048576
buffer_store_dwordx4 v[32:35], v36, s[16:19], s3 offen sc1
s_add_u32 s3, s3, 1048576
s_xor_b32 s3, s60, 1
s_mov_b32 s78, 135168
s_mov_b32 s79, 4224
s_and_b32 s5, s61, 7
s_cmp_eq_u32 s5, 1
s_cselect_b32 s78, 794624, s78
s_cselect_b32 s79, 8320, s79
s_cmp_eq_u32 s5, 2
s_cselect_b32 s78, 1060864, s78
s_cselect_b32 s79, 8320, s79
s_cmp_eq_u32 s5, 3
s_cselect_b32 s78, 1327104, s78
s_cselect_b32 s79, 8320, s79
s_cmp_eq_u32 s5, 4
s_cselect_b32 s78, 1593344, s78
s_cselect_b32 s79, 4096, s79
s_cmp_eq_u32 s5, 5
s_cselect_b32 s78, 1986560, s78
s_cselect_b32 s79, 8192, s79
s_cmp_eq_u32 s5, 6
s_cselect_b32 s78, 2248704, s78
s_cselect_b32 s79, 8192, s79
s_cmp_eq_u32 s5, 7
s_cselect_b32 s78, 135168, s78
s_cselect_b32 s79, 4224, s79
s_mul_i32 s3, s3, s79
s_add_u32 s3, s3, s78
s_sub_u32 s79, s79, 4
v_lshlrev_b32 v38, 2, v0
v_min_u32 v38, s79, v38
s_mov_b32 m0, 29440
s_nop 0
buffer_load_dword v38, s[8:11], s3 offen lds
v_bfe_u32 v34, v0, 8, 2
v_lshlrev_b32 v35, 5, v34
v_add_u32 v35, 0, v35
v_xor_b32 v35, v35, v0
v_and_b32 v35, 0xf0, v35
v_lshl_add_u32 v35, v34, 10, v35
s_lshl_b32 s78, s62, 8
s_add_u32 s78, s78, 0
s_lshl_b32 s79, s62, 14
s_add_u32 m0, s79, 98304
s_nop 0
buffer_load_dwordx4 v35, s[44:47], s78 offen lds
v_bfe_u32 v34, v0, 8, 2
s_nop 0
v_lshlrev_b32 v35, 5, v34
v_add_u32 v35, 128, v35
v_xor_b32 v35, v35, v0
v_and_b32 v35, 0xf0, v35
v_lshl_add_u32 v35, v34, 10, v35
s_lshl_b32 s78, s62, 8
s_add_u32 s78, s78, 4096
s_lshl_b32 s79, s62, 14
s_add_u32 m0, s79, 99328
s_nop 0
buffer_load_dwordx4 v35, s[44:47], s78 offen lds
v_bfe_u32 v34, v0, 8, 2
s_nop 0
v_lshlrev_b32 v35, 5, v34
v_add_u32 v35, 16, v35
v_xor_b32 v35, v35, v0
v_and_b32 v35, 0xf0, v35
v_lshl_add_u32 v35, v34, 10, v35
s_lshl_b32 s78, s62, 8
s_add_u32 s78, s78, 8192
s_lshl_b32 s79, s62, 14
s_add_u32 m0, s79, 100352
s_nop 0
buffer_load_dwordx4 v35, s[44:47], s78 offen lds
v_bfe_u32 v34, v0, 8, 2
s_nop 0
v_lshlrev_b32 v35, 5, v34
v_add_u32 v35, 144, v35
v_xor_b32 v35, v35, v0
v_and_b32 v35, 0xf0, v35
v_lshl_add_u32 v35, v34, 10, v35
s_lshl_b32 s78, s62, 8
s_add_u32 s78, s78, 12288
s_lshl_b32 s79, s62, 14
s_add_u32 m0, s79, 101376
s_nop 0
buffer_load_dwordx4 v35, s[44:47], s78 offen lds
v_bfe_u32 v34, v0, 8, 2
s_nop 0
v_lshlrev_b32 v35, 5, v34
v_add_u32 v35, 0, v35
v_xor_b32 v35, v35, v0
v_and_b32 v35, 0xf0, v35
v_lshl_add_u32 v35, v34, 10, v35
s_lshl_b32 s78, s62, 8
s_add_u32 s78, s78, 16384
s_lshl_b32 s79, s62, 14
s_add_u32 m0, s79, 102400
s_nop 0
buffer_load_dwordx4 v35, s[44:47], s78 offen lds
v_bfe_u32 v34, v0, 8, 2
s_nop 0
v_lshlrev_b32 v35, 5, v34
v_add_u32 v35, 128, v35
v_xor_b32 v35, v35, v0
v_and_b32 v35, 0xf0, v35
v_lshl_add_u32 v35, v34, 10, v35
s_lshl_b32 s78, s62, 8
s_add_u32 s78, s78, 20480
s_lshl_b32 s79, s62, 14
s_add_u32 m0, s79, 103424
s_nop 0
buffer_load_dwordx4 v35, s[44:47], s78 offen lds
v_bfe_u32 v34, v0, 8, 2
s_nop 0
v_lshlrev_b32 v35, 5, v34
v_add_u32 v35, 16, v35
v_xor_b32 v35, v35, v0
v_and_b32 v35, 0xf0, v35
v_lshl_add_u32 v35, v34, 10, v35
s_lshl_b32 s78, s62, 8
s_add_u32 s78, s78, 24576
s_lshl_b32 s79, s62, 14
s_add_u32 m0, s79, 104448
s_nop 0
buffer_load_dwordx4 v35, s[44:47], s78 offen lds
v_bfe_u32 v34, v0, 8, 2
s_nop 0
v_lshlrev_b32 v35, 5, v34
v_add_u32 v35, 144, v35
v_xor_b32 v35, v35, v0
v_and_b32 v35, 0xf0, v35
v_lshl_add_u32 v35, v34, 10, v35
s_lshl_b32 s78, s62, 8
s_add_u32 s78, s78, 28672
s_lshl_b32 s79, s62, 14
s_add_u32 m0, s79, 105472
s_nop 0
buffer_load_dwordx4 v35, s[44:47], s78 offen lds
v_bfe_u32 v34, v0, 8, 2
s_nop 0
v_lshlrev_b32 v35, 5, v34
v_add_u32 v35, 0, v35
v_xor_b32 v35, v35, v0
v_and_b32 v35, 0xf0, v35
v_lshl_add_u32 v35, v34, 10, v35
s_lshl_b32 s78, s62, 8
s_add_u32 s78, s78, 32768
s_lshl_b32 s79, s62, 14
s_add_u32 m0, s79, 106496
s_nop 0
buffer_load_dwordx4 v35, s[44:47], s78 offen lds
v_bfe_u32 v34, v0, 8, 2
s_nop 0
v_lshlrev_b32 v35, 5, v34
v_add_u32 v35, 128, v35
v_xor_b32 v35, v35, v0
v_and_b32 v35, 0xf0, v35
v_lshl_add_u32 v35, v34, 10, v35
s_lshl_b32 s78, s62, 8
s_add_u32 s78, s78, 36864
s_lshl_b32 s79, s62, 14
s_add_u32 m0, s79, 107520
s_nop 0
buffer_load_dwordx4 v35, s[44:47], s78 offen lds
v_bfe_u32 v34, v0, 8, 2
s_nop 0
v_lshlrev_b32 v35, 5, v34
v_add_u32 v35, 16, v35
v_xor_b32 v35, v35, v0
v_and_b32 v35, 0xf0, v35
v_lshl_add_u32 v35, v34, 10, v35
s_lshl_b32 s78, s62, 8
s_add_u32 s78, s78, 40960
s_lshl_b32 s79, s62, 14
s_add_u32 m0, s79, 108544
s_nop 0
buffer_load_dwordx4 v35, s[44:47], s78 offen lds
v_bfe_u32 v34, v0, 8, 2
s_nop 0
v_lshlrev_b32 v35, 5, v34
v_add_u32 v35, 144, v35
v_xor_b32 v35, v35, v0
v_and_b32 v35, 0xf0, v35
v_lshl_add_u32 v35, v34, 10, v35
s_lshl_b32 s78, s62, 8
s_add_u32 s78, s78, 45056
s_lshl_b32 s79, s62, 14
s_add_u32 m0, s79, 109568
s_nop 0
buffer_load_dwordx4 v35, s[44:47], s78 offen lds
v_bfe_u32 v34, v0, 8, 2
s_nop 0
v_lshlrev_b32 v35, 5, v34
v_add_u32 v35, 0, v35
v_xor_b32 v35, v35, v0
v_and_b32 v35, 0xf0, v35
v_lshl_add_u32 v35, v34, 10, v35
s_lshl_b32 s78, s62, 8
s_add_u32 s78, s78, 49152
s_lshl_b32 s79, s62, 14
s_add_u32 m0, s79, 110592
s_nop 0
buffer_load_dwordx4 v35, s[44:47], s78 offen lds
v_bfe_u32 v34, v0, 8, 2
s_nop 0
v_lshlrev_b32 v35, 5, v34
v_add_u32 v35, 128, v35
v_xor_b32 v35, v35, v0
v_and_b32 v35, 0xf0, v35
v_lshl_add_u32 v35, v34, 10, v35
s_lshl_b32 s78, s62, 8
s_add_u32 s78, s78, 53248
s_lshl_b32 s79, s62, 14
s_add_u32 m0, s79, 111616
s_nop 0
buffer_load_dwordx4 v35, s[44:47], s78 offen lds
v_bfe_u32 v34, v0, 8, 2
s_nop 0
v_lshlrev_b32 v35, 5, v34
v_add_u32 v35, 16, v35
v_xor_b32 v35, v35, v0
v_and_b32 v35, 0xf0, v35
v_lshl_add_u32 v35, v34, 10, v35
s_lshl_b32 s78, s62, 8
s_add_u32 s78, s78, 57344
s_lshl_b32 s79, s62, 14
s_add_u32 m0, s79, 112640
s_nop 0
buffer_load_dwordx4 v35, s[44:47], s78 offen lds
v_bfe_u32 v34, v0, 8, 2
s_nop 0
v_lshlrev_b32 v35, 5, v34
v_add_u32 v35, 144, v35
v_xor_b32 v35, v35, v0
v_and_b32 v35, 0xf0, v35
v_lshl_add_u32 v35, v34, 10, v35
s_lshl_b32 s78, s62, 8
s_add_u32 s78, s78, 61440
s_lshl_b32 s79, s62, 14
s_add_u32 m0, s79, 113664
s_nop 0
buffer_load_dwordx4 v35, s[44:47], s78 offen lds
s_sleep 2
s_mov_b32 s80, 0
buffer_load_dwordx2 v[12:13], v41, s[8:11], s81 offen
buffer_load_dwordx4 v[8:11], v0, s[8:11], s81 offen
s_waitcnt vmcnt(0)
P_5:
v_max3_u32 v18, v8, v9, v13
v_max3_u32 v18, v18, v10, v11
v_max3_u32 v18, v18, v12, v13
v_cmp_eq_u32 vcc, -1, v18
s_nop 0
s_cbranch_vccnz R_7
D_6:
v_max_f32_dpp v18, v12, v12 quad_perm:[1,0,3,2] row_mask:0xf bank_mask:0xf
s_nop 1
v_max_f32_dpp v18, v18, v18 quad_perm:[2,3,0,1] row_mask:0xf bank_mask:0xf
v_sub_f32 v12, v12, v18
v_exp_f32 v12, v12
s_nop 0
v_mul_f32 v13, v12, v13
v_mul_f32 v8, v12, v8
v_mul_f32 v9, v12, v9
v_mul_f32 v10, v12, v10
v_mul_f32 v11, v12, v11
v_add_f32_dpp v13, v13, v13 quad_perm:[1,0,3,2] row_mask:0xf bank_mask:0xf
v_add_f32_dpp v8, v8, v8 quad_perm:[1,0,3,2] row_mask:0xf bank_mask:0xf
v_add_f32_dpp v9, v9, v9 quad_perm:[1,0,3,2] row_mask:0xf bank_mask:0xf
v_add_f32_dpp v10, v10, v10 quad_perm:[1,0,3,2] row_mask:0xf bank_mask:0xf
v_add_f32_dpp v11, v11, v11 quad_perm:[1,0,3,2] row_mask:0xf bank_mask:0xf
v_add_f32_dpp v13, v13, v13 quad_perm:[2,3,0,1] row_mask:0xf bank_mask:0xf
v_rcp_f32 v13, v13
v_add_f32_dpp v8, v8, v8 quad_perm:[2,3,0,1] row_mask:0xf bank_mask:0xf
v_add_f32_dpp v9, v9, v9 quad_perm:[2,3,0,1] row_mask:0xf bank_mask:0xf
v_add_f32_dpp v10, v10, v10 quad_perm:[2,3,0,1] row_mask:0xf bank_mask:0xf
v_add_f32_dpp v11, v11, v11 quad_perm:[2,3,0,1] row_mask:0xf bank_mask:0xf
v_mul_f32 v8, v13, v8
v_mul_f32 v9, v13, v9
v_mul_f32 v10, v13, v10
v_mul_f32 v11, v13, v11
v_cvt_pk_bf16_f32 v8, v8, v9
v_cvt_pk_bf16_f32 v9, v10, v11
v_perm_b32 v12, v8, v8, v1
v_perm_b32 v13, v8, v8, v2
v_cndmask_b32 v16, 0, v12, s[72:73]
v_cndmask_b32 v17, 0, v12, s[74:75]
v_cndmask_b32 v18, 0, v13, s[72:73]
v_cndmask_b32 v19, 0, v13, s[74:75]
v_perm_b32 v14, v9, v9, v1
v_perm_b32 v15, v9, v9, v2
v_cndmask_b32 v20, 0, v14, s[72:73]
v_cndmask_b32 v21, 0, v14, s[74:75]
v_cndmask_b32 v22, 0, v15, s[72:73]
v_cndmask_b32 v23, 0, v15, s[74:75]
v_mfma_f32_16x16x32_bf16 v[36:39], v[16:19], v[48:51], 0
v_cndmask_b32 v24, 0, v12, s[96:97]
v_cndmask_b32 v25, 0, v12, s[98:99]
v_cndmask_b32 v26, 0, v13, s[96:97]
v_cndmask_b32 v27, 0, v13, s[98:99]
v_mfma_f32_16x16x32_bf16 v[36:39], v[20:23], v[52:55], v[36:39]
v_cndmask_b32 v28, 0, v14, s[96:97]
v_cndmask_b32 v29, 0, v14, s[98:99]
v_cndmask_b32 v30, 0, v15, s[96:97]
v_cndmask_b32 v31, 0, v15, s[98:99]
v_mfma_f32_16x16x32_bf16 v[36:39], v[24:27], v[56:59], v[36:39]
s_nop 0
v_mfma_f32_16x16x32_bf16 v[36:39], v[28:31], v[60:63], v[36:39]
s_nop 7
ds_write_b128 v0, v[36:39] offset:4096
buffer_load_dwordx4 v[48:51], v46, s[28:31], s86 offen
buffer_load_dwordx4 v[52:55], v46, s[28:31], s87 offen
buffer_load_dwordx4 v[56:59], v46, s[28:31], s88 offen
buffer_load_dwordx4 v[60:63], v46, s[28:31], s89 offen
s_waitcnt lgkmcnt(0)
s_barrier
s_cmp_lg_u32 s62, 0
s_cbranch_scc1 S_11
ds_read_b128 v[8:11], v0 offset:4096
ds_read_b128 v[12:15], v0 offset:4608
ds_read_b128 v[16:19], v0 offset:5120
ds_read_b128 v[20:23], v0 offset:5632
ds_read_b128 v[24:27], v0 offset:6144
ds_read_b128 v[28:31], v0 offset:6656
ds_read_b128 v[32:35], v0 offset:7168
ds_read_b128 v[36:39], v0 offset:7680
s_waitcnt lgkmcnt(6)
v_pk_add_f32 v[8:9], v[8:9], v[12:13]
v_pk_add_f32 v[10:11], v[10:11], v[14:15]
s_waitcnt lgkmcnt(4)
v_pk_add_f32 v[16:17], v[16:17], v[20:21]
v_pk_add_f32 v[18:19], v[18:19], v[22:23]
s_waitcnt lgkmcnt(2)
v_pk_add_f32 v[24:25], v[24:25], v[28:29]
v_pk_add_f32 v[26:27], v[26:27], v[30:31]
s_waitcnt lgkmcnt(0)
v_pk_add_f32 v[32:33], v[32:33], v[36:37]
v_pk_add_f32 v[34:35], v[34:35], v[38:39]
v_pk_add_f32 v[8:9], v[8:9], v[16:17]
v_pk_add_f32 v[10:11], v[10:11], v[18:19]
v_pk_add_f32 v[24:25], v[24:25], v[32:33]
v_pk_add_f32 v[26:27], v[26:27], v[34:35]
v_pk_add_f32 v[8:9], v[8:9], v[24:25]
v_pk_add_f32 v[10:11], v[10:11], v[26:27]
s_mov_b32 exec_lo, -1
s_mov_b32 exec_hi, 0
buffer_store_dwordx4 v[8:11], v44, s[16:19], s4 offen sc1
s_mov_b64 exec, -1
S_11:
s_nop 0
v_bfe_u32 v44, v0, 4, 4
v_lshlrev_b32 v44, 8, v44
v_bfe_u32 v47, v0, 8, 1
v_lshl_add_u32 v44, v47, 7, v44
v_bfe_u32 v47, v0, 9, 1
v_lshl_add_u32 v44, v47, 6, v44
s_mov_b32 s4, 794624
s_bfe_u32 s3, s60, 327680
s_mul_i32 s3, s3, 8320
s_add_u32 s4, s4, s3
s_bfe_u32 s3, s61, 65538
s_mul_i32 s3, s3, 4096
s_add_u32 s4, s4, s3
s_bfe_u32 s3, s61, 131072
s_mul_i32 s3, s3, 16
s_add_u32 s4, s4, s3
s_mov_b32 s100, 802816
s_bfe_u32 s3, s60, 327680
s_mul_i32 s3, s3, 8320
s_add_u32 s100, s100, s3
s_bfe_u32 s3, s61, 196608
s_mul_i32 s3, s3, 16
s_add_u32 s100, s100, s3
v_bfe_u32 v46, v0, 4, 4
v_lshlrev_b32 v46, 13, v46
v_bfe_u32 v47, v0, 8, 2
v_lshl_add_u32 v46, v47, 4, v46
v_bfe_u32 v47, v0, 10, 2
v_lshl_add_u32 v46, v47, 17, v46
v_bfe_u32 v45, v0, 9, 1
v_lshlrev_b32 v45, 3, v45
v_mov_b32 v28, 0x3f803f80
v_mov_b32 v29, v28
v_mov_b32 v30, v28
v_mov_b32 v31, v28
s_mov_b32 s81, 270336
s_bfe_u32 s3, s61, 196608
s_mul_i32 s3, s3, 16384
s_add_u32 s81, s81, s3
s_bfe_u32 s3, s62, 131072
s_mul_i32 s3, s3, 3072
s_add_u32 s81, s81, s3
s_barrier
s_sleep 24
s_mov_b32 s80, 0
buffer_load_dwordx4 v[8:11], v0, s[16:19], s81 offen offset:0 sc1
buffer_load_dwordx4 v[12:15], v0, s[16:19], s81 offen offset:1024 sc1
buffer_load_dwordx4 v[16:19], v0, s[16:19], s81 offen offset:2048 sc1
buffer_load_dwordx4 v[20:23], v0, s[16:19], s81 offen offset:3072 sc1
v_perm_b32 v27, v28, v28, v1
v_cndmask_b32 v32, 0, v27, s[64:65]
v_cndmask_b32 v33, 0, v27, s[66:67]
v_cndmask_b32 v34, 0, v27, s[68:69]
v_cndmask_b32 v35, 0, v27, s[70:71]
s_waitcnt vmcnt(4)
s_nop 0
v_mfma_f32_16x16x32_bf16 v[36:39], v[32:35], v[48:51], 0
v_mfma_f32_16x16x32_bf16 v[36:39], v[32:35], v[52:55], v[36:39]
v_mfma_f32_16x16x32_bf16 v[36:39], v[32:35], v[56:59], v[36:39]
v_mfma_f32_16x16x32_bf16 v[36:39], v[32:35], v[60:63], v[36:39]
s_nop 7
ds_write_b128 v0, v[36:39] offset:8192
v_bfe_u32 v38, v0, 4, 1
v_lshlrev_b32 v38, 7, v38
v_bfe_u32 v47, v0, 6, 6
v_lshl_add_u32 v38, v47, 13, v38
s_mov_b32 m0, 29440
s_nop 0
buffer_load_dword v38, s[32:35], 0 offen lds
s_waitcnt vmcnt(1)
P_12:
v_max3_u32 v24, v8, v9, v23
v_max3_u32 v24, v24, v10, v11
v_max3_u32 v24, v24, v12, v13
v_max3_u32 v24, v24, v14, v15
v_max3_u32 v24, v24, v16, v17
v_max3_u32 v24, v24, v18, v19
v_max3_u32 v24, v24, v20, v21
v_max3_u32 v24, v24, v22, v23
v_cmp_eq_u32 vcc, -1, v24
s_nop 0
s_cbranch_vccnz R_14
D_13:
v_pk_add_f32 v[8:9], v[8:9], v[12:13]
v_pk_add_f32 v[16:17], v[16:17], v[20:21]
v_pk_add_f32 v[10:11], v[10:11], v[14:15]
v_pk_add_f32 v[18:19], v[18:19], v[22:23]
v_pk_add_f32 v[8:9], v[8:9], v[16:17]
v_pk_add_f32 v[10:11], v[10:11], v[18:19]
s_nop 0
v_add_f32_dpp v8, v8, v8 quad_perm:[1,0,3,2] row_mask:0xf bank_mask:0xf
v_add_f32_dpp v9, v9, v9 quad_perm:[1,0,3,2] row_mask:0xf bank_mask:0xf
v_add_f32_dpp v10, v10, v10 quad_perm:[1,0,3,2] row_mask:0xf bank_mask:0xf
v_add_f32_dpp v11, v11, v11 quad_perm:[1,0,3,2] row_mask:0xf bank_mask:0xf
v_add_f32_dpp v8, v8, v8 quad_perm:[2,3,0,1] row_mask:0xf bank_mask:0xf
v_add_f32_dpp v9, v9, v9 quad_perm:[2,3,0,1] row_mask:0xf bank_mask:0xf
v_add_f32_dpp v10, v10, v10 quad_perm:[2,3,0,1] row_mask:0xf bank_mask:0xf
v_add_f32_dpp v11, v11, v11 quad_perm:[2,3,0,1] row_mask:0xf bank_mask:0xf
v_add_f32_dpp v8, v8, v8 row_half_mirror row_mask:0xf bank_mask:0xf
v_add_f32_dpp v9, v9, v9 row_half_mirror row_mask:0xf bank_mask:0xf
v_add_f32_dpp v10, v10, v10 row_half_mirror row_mask:0xf bank_mask:0xf
v_add_f32_dpp v11, v11, v11 row_half_mirror row_mask:0xf bank_mask:0xf
v_cvt_pk_bf16_f32 v8, v8, v9
v_cvt_pk_bf16_f32 v9, v10, v11
v_lshlrev_b32 v10, 16, v8
v_and_b32 v11, s83, v8
v_lshlrev_b32 v12, 16, v9
v_and_b32 v13, s83, v9
v_pk_add_f32 v[4:5], v[4:5], v[10:11]
v_pk_add_f32 v[6:7], v[6:7], v[12:13]
v_cvt_pk_bf16_f32 v8, v4, v5
v_cvt_pk_bf16_f32 v9, v6, v7
v_perm_b32 v10, v8, v8, v1
v_cndmask_b32 v12, 0, v10, s[64:65]
v_cndmask_b32 v13, 0, v10, s[66:67]
v_cndmask_b32 v14, 0, v10, s[68:69]
v_cndmask_b32 v15, 0, v10, s[70:71]
v_perm_b32 v10, v8, v8, v2
v_cndmask_b32 v16, 0, v10, s[64:65]
v_cndmask_b32 v17, 0, v10, s[66:67]
v_cndmask_b32 v18, 0, v10, s[68:69]
v_cndmask_b32 v19, 0, v10, s[70:71]
v_mfma_f32_16x16x32_bf16 v[36:39], v[12:15], v[48:51], 0
v_mfma_f32_16x16x32_bf16 v[40:43], v[12:15], v[28:31], 0
v_mfma_f32_16x16x32_bf16 v[32:35], v[12:15], v[12:15], 0
v_perm_b32 v10, v9, v9, v1
v_cndmask_b32 v20, 0, v10, s[64:65]
v_cndmask_b32 v21, 0, v10, s[66:67]
v_cndmask_b32 v22, 0, v10, s[68:69]
v_cndmask_b32 v23, 0, v10, s[70:71]
v_mfma_f32_16x16x32_bf16 v[36:39], v[16:19], v[52:55], v[36:39]
v_mfma_f32_16x16x32_bf16 v[40:43], v[16:19], v[28:31], v[40:43]
v_mfma_f32_16x16x32_bf16 v[32:35], v[16:19], v[16:19], v[32:35]
v_perm_b32 v10, v9, v9, v2
v_cndmask_b32 v24, 0, v10, s[64:65]
v_cndmask_b32 v25, 0, v10, s[66:67]
v_cndmask_b32 v26, 0, v10, s[68:69]
v_cndmask_b32 v27, 0, v10, s[70:71]
v_mfma_f32_16x16x32_bf16 v[36:39], v[20:23], v[56:59], v[36:39]
v_mfma_f32_16x16x32_bf16 v[40:43], v[20:23], v[28:31], v[40:43]
v_mfma_f32_16x16x32_bf16 v[32:35], v[20:23], v[20:23], v[32:35]
v_mfma_f32_16x16x32_bf16 v[36:39], v[24:27], v[60:63], v[36:39]
v_mfma_f32_16x16x32_bf16 v[40:43], v[24:27], v[28:31], v[40:43]
v_mfma_f32_16x16x32_bf16 v[32:35], v[24:27], v[24:27], v[32:35]
v_lshlrev_b32 v4, 16, v8
v_and_b32 v5, s83, v8
v_lshlrev_b32 v6, 16, v9
v_and_b32 v7, s83, v9
s_nop 1
ds_write_b128 v0, v[36:39] offset:0
s_nop 0
v_mov_b32 v41, v32
ds_write_b64 v0, v[40:41] offset:24576
buffer_load_dwordx4 v[48:51], v46, s[32:35], 0 offen offset:0
buffer_load_dwordx4 v[52:55], v46, s[32:35], 0 offen offset:64
buffer_load_dwordx4 v[56:59], v46, s[32:35], 0 offen offset:128
buffer_load_dwordx4 v[60:63], v46, s[32:35], 0 offen offset:192
s_waitcnt lgkmcnt(0)
s_barrier
s_cmp_lg_u32 s62, 0
s_cbranch_scc1 S_19
ds_read_b128 v[8:11], v0 offset:0
ds_read_b128 v[12:15], v0 offset:1024
ds_read_b128 v[16:19], v0 offset:2048
ds_read_b128 v[20:23], v0 offset:3072
s_waitcnt lgkmcnt(2)
v_pk_add_f32 v[8:9], v[8:9], v[12:13]
v_pk_add_f32 v[10:11], v[10:11], v[14:15]
s_waitcnt lgkmcnt(0)
v_pk_add_f32 v[16:17], v[16:17], v[20:21]
v_pk_add_f32 v[18:19], v[18:19], v[22:23]
v_pk_add_f32 v[8:9], v[8:9], v[16:17]
v_pk_add_f32 v[10:11], v[10:11], v[18:19]
buffer_store_dwordx4 v[8:11], v44, s[8:11], s4 offen
buffer_store_dwordx4 v[8:11], v44, s[16:19], s4 offen sc1
s_mov_b64 exec, -1
S_19:
v_bfe_u32 v43, v0, 4, 4
v_lshlrev_b32 v43, 7, v43
v_bfe_u32 v47, v0, 8, 1
v_lshl_add_u32 v43, v47, 6, v43
s_mov_b32 s4, 1593344
s_bfe_u32 s3, s60, 327680
s_mul_i32 s3, s3, 4096
s_add_u32 s4, s4, s3
s_bfe_u32 s3, s61, 65538
s_mul_i32 s3, s3, 2048
s_add_u32 s4, s4, s3
s_bfe_u32 s3, s61, 131072
s_mul_i32 s3, s3, 16
s_add_u32 s4, s4, s3
s_cmp_lg_u32 s62, 1
s_cbranch_scc1 S_20
ds_read_b128 v[8:11], v0 offset:7168
ds_read_b128 v[12:15], v0 offset:8192
ds_read_b128 v[16:19], v0 offset:9216
ds_read_b128 v[20:23], v0 offset:10240
s_waitcnt lgkmcnt(2)
v_pk_add_f32 v[8:9], v[8:9], v[12:13]
v_pk_add_f32 v[10:11], v[10:11], v[14:15]
s_waitcnt lgkmcnt(0)
v_pk_add_f32 v[16:17], v[16:17], v[20:21]
v_pk_add_f32 v[18:19], v[18:19], v[22:23]
v_pk_add_f32 v[8:9], v[8:9], v[16:17]
v_pk_add_f32 v[10:11], v[10:11], v[18:19]
s_mov_b32 exec_lo, -1
s_mov_b32 exec_hi, 0
buffer_store_dwordx4 v[8:11], v43, s[8:11], s4 offen
buffer_store_dwordx4 v[8:11], v43, s[16:19], s4 offen sc1
s_mov_b64 exec, -1
S_20:
s_cmp_lg_u32 s62, 2
s_cbranch_scc1 S_21
ds_read_b64 v[8:9], v0 offset:22528
ds_read_b64 v[12:13], v0 offset:23552
ds_read_b64 v[16:17], v0 offset:24576
ds_read_b64 v[20:21], v0 offset:25600
s_waitcnt lgkmcnt(2)
v_pk_add_f32 v[8:9], v[8:9], v[12:13]
s_waitcnt lgkmcnt(0)
v_pk_add_f32 v[16:17], v[16:17], v[20:21]
v_pk_add_f32 v[8:9], v[8:9], v[16:17]
s_mov_b32 exec_lo, 1
s_mov_b32 exec_hi, 256
buffer_store_dwordx2 v[8:9], v45, s[8:11], s100 offen
buffer_store_dwordx2 v[8:9], v45, s[16:19], s100 offen sc1
s_mov_b64 exec, -1
S_21:
v_bfe_u32 v41, v0, 4, 2
v_lshlrev_b32 v41, 4, v41
v_bfe_u32 v47, v0, 6, 1
v_lshl_add_u32 v41, v47, 3, v41
v_add_u32 v41, 8192, v41
s_mov_b32 s81, 794624
s_bfe_u32 s3, s60, 327680
s_mul_i32 s3, s3, 8320
s_add_u32 s81, s81, s3
s_add_u32 s100, s81, 4096
v_bfe_u32 v42, v0, 6, 1
v_lshlrev_b32 v42, 8, v42
v_bfe_u32 v47, v0, 7, 5
v_lshl_add_u32 v42, v47, 3, v42
v_add_u32 v42, 28672, v42
v_bfe_u32 v39, v0, 7, 5
v_lshlrev_b32 v39, 4, v39
v_add_u32 v39, 30208, v39
v_bfe_u32 v40, v0, 4, 2
v_lshlrev_b32 v40, 4, v40
v_bfe_u32 v47, v0, 7, 5
v_lshl_add_u32 v40, v47, 6, v40
s_mov_b32 s101, 1593344
s_bfe_u32 s3, s60, 327680
s_mul_i32 s3, s3, 4096
s_add_u32 s101, s101, s3
v_bfe_u32 v43, v0, 4, 1
v_lshlrev_b32 v43, 8, v43
v_bfe_u32 v47, v0, 8, 2
v_lshl_add_u32 v43, v47, 4, v43
v_add_u32 v43, 28672, v43
v_bfe_u32 v44, v0, 4, 1
v_lshlrev_b32 v44, 15, v44
v_bfe_u32 v47, v0, 8, 1
v_lshl_add_u32 v44, v47, 3, v44
v_bfe_u32 v47, v0, 9, 1
v_lshl_add_u32 v44, v47, 10, v44
v_bfe_u32 v47, v0, 10, 1
v_lshl_add_u32 v44, v47, 11, v44
v_bfe_u32 v47, v0, 11, 1
v_lshl_add_u32 v44, v47, 8, v44
s_mov_b32 s4, 1789952
s_bfe_u32 s3, s60, 65540
s_mul_i32 s3, s3, 16384
s_add_u32 s4, s4, s3
s_bfe_u32 s3, s61, 131073
s_mul_i32 s3, s3, 4096
s_add_u32 s4, s4, s3
s_bfe_u32 s3, s61, 65536
s_mul_i32 s3, s3, 512
s_add_u32 s4, s4, s3
s_bfe_u32 s3, s60, 262144
s_mul_i32 s3, s3, 16
s_add_u32 s4, s4, s3
s_barrier
s_sleep 8
s_mov_b32 s80, 0
buffer_load_dwordx2 v[16:17], v41, s[8:11], s81 offen
buffer_load_dwordx2 v[18:19], v41, s[8:11], s81 offen offset:64
buffer_load_dwordx4 v[8:11], v0, s[8:11], s81 offen
buffer_load_dwordx4 v[12:15], v0, s[8:11], s100 offen
buffer_load_dwordx4 v[20:23], v40, s[8:11], s101 offen offset:0
buffer_load_dwordx4 v[24:27], v40, s[8:11], s101 offen offset:2048
v_bfe_u32 v38, v0, 4, 1
v_lshlrev_b32 v38, 7, v38
v_bfe_u32 v47, v0, 6, 3
v_lshl_add_u32 v38, v47, 13, v38
v_bfe_u32 v47, v0, 9, 3
v_lshl_add_u32 v38, v47, 17, v38
s_mov_b32 m0, 29440
s_nop 0
buffer_load_dword v38, s[36:39], 0 offen lds
s_waitcnt vmcnt(1)
P_22:
v_max3_u32 v30, v8, v9, v27
v_max3_u32 v30, v30, v10, v11
v_max3_u32 v30, v30, v12, v13
v_max3_u32 v30, v30, v14, v15
v_max3_u32 v30, v30, v16, v17
v_max3_u32 v30, v30, v18, v19
v_max3_u32 v30, v30, v20, v21
v_max3_u32 v30, v30, v22, v23
v_max3_u32 v30, v30, v24, v25
v_max3_u32 v30, v30, v26, v27
v_cmp_eq_u32 vcc, -1, v30
s_nop 0
s_cbranch_vccnz R_24
D_23:
v_pk_add_f32 v[16:17], v[16:17], v[18:19]
v_pk_add_f32 v[8:9], v[8:9], v[12:13]
v_pk_add_f32 v[10:11], v[10:11], v[14:15]
v_pk_add_f32 v[20:21], v[20:21], v[24:25]
v_pk_add_f32 v[22:23], v[22:23], v[26:27]
v_add_f32_dpp v16, v16, v16 quad_perm:[1,0,3,2] row_mask:0xf bank_mask:0xf
v_add_f32_dpp v17, v17, v17 quad_perm:[1,0,3,2] row_mask:0xf bank_mask:0xf
v_add_f32_dpp v8, v8, v8 quad_perm:[1,0,3,2] row_mask:0xf bank_mask:0xf
v_add_f32_dpp v9, v9, v9 quad_perm:[1,0,3,2] row_mask:0xf bank_mask:0xf
v_add_f32_dpp v10, v10, v10 quad_perm:[1,0,3,2] row_mask:0xf bank_mask:0xf
v_add_f32_dpp v11, v11, v11 quad_perm:[1,0,3,2] row_mask:0xf bank_mask:0xf
v_add_f32_dpp v20, v20, v20 quad_perm:[1,0,3,2] row_mask:0xf bank_mask:0xf
v_add_f32_dpp v21, v21, v21 quad_perm:[1,0,3,2] row_mask:0xf bank_mask:0xf
v_add_f32_dpp v22, v22, v22 quad_perm:[1,0,3,2] row_mask:0xf bank_mask:0xf
v_add_f32_dpp v23, v23, v23 quad_perm:[1,0,3,2] row_mask:0xf bank_mask:0xf
v_add_f32_dpp v16, v16, v16 quad_perm:[2,3,0,1] row_mask:0xf bank_mask:0xf
v_add_f32_dpp v17, v17, v17 quad_perm:[2,3,0,1] row_mask:0xf bank_mask:0xf
v_add_f32_dpp v8, v8, v8 quad_perm:[2,3,0,1] row_mask:0xf bank_mask:0xf
v_add_f32_dpp v9, v9, v9 quad_perm:[2,3,0,1] row_mask:0xf bank_mask:0xf
v_add_f32_dpp v10, v10, v10 quad_perm:[2,3,0,1] row_mask:0xf bank_mask:0xf
v_add_f32_dpp v11, v11, v11 quad_perm:[2,3,0,1] row_mask:0xf bank_mask:0xf
v_add_f32_dpp v20, v20, v20 quad_perm:[2,3,0,1] row_mask:0xf bank_mask:0xf
v_add_f32_dpp v21, v21, v21 quad_perm:[2,3,0,1] row_mask:0xf bank_mask:0xf
v_add_f32_dpp v22, v22, v22 quad_perm:[2,3,0,1] row_mask:0xf bank_mask:0xf
v_add_f32_dpp v23, v23, v23 quad_perm:[2,3,0,1] row_mask:0xf bank_mask:0xf
v_mul_f32 v16, s91, v16
v_mul_f32 v17, s91, v17
v_fma_f32 v17, -v16, v16, v17
v_max_f32 v17, 0, v17
v_add_f32 v17, s92, v17
v_rsq_f32 v17, v17
s_waitcnt lgkmcnt(0)
v_fma_f32 v8, -v16, v20, v8
v_fma_f32 v9, -v16, v21, v9
v_fma_f32 v10, -v16, v22, v10
v_fma_f32 v11, -v16, v23, v11
v_mul_f32 v8, v17, v8
v_mul_f32 v9, v17, v9
v_mul_f32 v10, v17, v10
v_mul_f32 v11, v17, v11
v_cvt_pk_bf16_f32 v8, v8, v9
v_cvt_pk_bf16_f32 v9, v10, v11
ds_write_b64 v42, v[8:9]
s_waitcnt lgkmcnt(0)
s_barrier
ds_write_b128 v39, v[20:23]
ds_read_b128 v[8:11], v43 offset:0
ds_read_b128 v[12:15], v43 offset:64
ds_read_b128 v[16:19], v43 offset:128
ds_read_b128 v[20:23], v43 offset:192
s_waitcnt lgkmcnt(3)
v_mfma_f32_16x16x32_bf16 v[24:27], v[48:51], v[8:11], 0
s_waitcnt lgkmcnt(2)
v_mfma_f32_16x16x32_bf16 v[24:27], v[52:55], v[12:15], v[24:27]
s_waitcnt lgkmcnt(1)
v_mfma_f32_16x16x32_bf16 v[24:27], v[56:59], v[16:19], v[24:27]
s_waitcnt lgkmcnt(0)
v_mfma_f32_16x16x32_bf16 v[24:27], v[60:63], v[20:23], v[24:27]
s_mov_b32 exec_lo, 0x00030003
s_mov_b32 exec_hi, 0x00030003
s_nop 5
v_cvt_pk_bf16_f32 v24, v24, v25
v_cvt_pk_bf16_f32 v25, v26, v27
buffer_store_dwordx2 v[24:25], v44, s[16:19], s4 offen sc1
s_mov_b64 exec, -1
v_bfe_u32 v41, v0, 7, 1
v_bfe_u32 v42, v0, 4, 3
v_lshl_or_b32 v41, v42, 1, v41
v_bfe_u32 v42, v0, 8, 2
v_lshlrev_b32 v42, 2, v42
v_xor_b32 v41, v41, v42
v_bfe_u32 v40, v0, 4, 4
v_lshlrev_b32 v40, 8, v40
v_bfe_u32 v47, v0, 10, 2
v_lshl_add_u32 v40, v47, 14, v40
v_add_u32 v40, 98304, v40
v_lshl_add_u32 v40, v41, 4, v40
v_xor_b32 v41, 16, v40
v_xor_b32 v42, 32, v40
v_xor_b32 v43, 48, v40
s_mov_b32 s81, 1789952
s_bfe_u32 s3, s6, 65542
s_mul_i32 s3, s3, 32768
s_add_u32 s81, s81, s3
s_bfe_u32 s3, s7, 65536
s_mul_i32 s3, s3, 16384
s_add_u32 s81, s81, s3
s_bfe_u32 s3, s62, 131072
s_mul_i32 s3, s3, 3072
s_add_u32 s81, s81, s3
s_mov_b32 s4, 4194304
s_bfe_u32 s3, s6, 458752
s_mul_i32 s3, s3, 32768
s_add_u32 s4, s4, s3
s_bfe_u32 s3, s7, 65536
s_mul_i32 s3, s3, 16384
s_add_u32 s4, s4, s3
s_mov_b32 s100, 1921024
s_bfe_u32 s3, s6, 458752
s_mul_i32 s3, s3, 8
s_add_u32 s100, s100, s3
s_bfe_u32 s3, s7, 65536
s_mul_i32 s3, s3, 16384
s_add_u32 s100, s100, s3
ds_read_b128 v[44:47], v40 offset:0
ds_read_b128 v[48:51], v41 offset:0
ds_read_b128 v[52:55], v42 offset:0
ds_read_b128 v[56:59], v43 offset:0
ds_read_b128 v[60:63], v40 offset:4096
s_sleep 30
s_mov_b32 s80, 0
buffer_load_dwordx4 v[8:11], v0, s[16:19], s81 offen offset:0 sc1
buffer_load_dwordx4 v[12:15], v0, s[16:19], s81 offen offset:1024 sc1
buffer_load_dwordx4 v[16:19], v0, s[16:19], s81 offen offset:2048 sc1
buffer_load_dwordx4 v[20:23], v0, s[16:19], s81 offen offset:3072 sc1
v_bfe_u32 v38, v0, 5, 7
v_lshlrev_b32 v38, 10, v38
s_mov_b32 m0, 29440
s_nop 0
buffer_load_dword v38, s[40:43], 0 offen lds
s_waitcnt vmcnt(1)
P_32:
v_max3_u32 v24, v8, v9, v23
v_max3_u32 v24, v24, v10, v11
v_max3_u32 v24, v24, v12, v13
v_max3_u32 v24, v24, v14, v15
v_max3_u32 v24, v24, v16, v17
v_max3_u32 v24, v24, v18, v19
v_max3_u32 v24, v24, v20, v21
v_max3_u32 v24, v24, v22, v23
v_cmp_eq_u32 vcc, -1, v24
s_nop 0
s_cbranch_vccnz R_34
D_33:
s_waitcnt lgkmcnt(4)
v_mfma_f32_16x16x32_bf16 v[24:27], v[44:47], v[8:11], 0
ds_read_b128 v[44:47], v41 offset:4096
s_waitcnt lgkmcnt(4)
v_mfma_f32_16x16x32_bf16 v[24:27], v[48:51], v[12:15], v[24:27]
ds_read_b128 v[48:51], v42 offset:4096
s_waitcnt lgkmcnt(4)
v_mfma_f32_16x16x32_bf16 v[24:27], v[52:55], v[16:19], v[24:27]
ds_read_b128 v[52:55], v43 offset:4096
s_waitcnt lgkmcnt(4)
v_mfma_f32_16x16x32_bf16 v[24:27], v[56:59], v[20:23], v[24:27]
ds_read_b128 v[56:59], v40 offset:8192
s_waitcnt lgkmcnt(4)
v_mfma_f32_16x16x32_bf16 v[28:31], v[60:63], v[8:11], 0
ds_read_b128 v[60:63], v41 offset:8192
s_waitcnt lgkmcnt(4)
v_mfma_f32_16x16x32_bf16 v[28:31], v[44:47], v[12:15], v[28:31]
ds_read_b128 v[44:47], v42 offset:8192
s_waitcnt lgkmcnt(4)
v_mfma_f32_16x16x32_bf16 v[28:31], v[48:51], v[16:19], v[28:31]
ds_read_b128 v[48:51], v43 offset:8192
s_waitcnt lgkmcnt(4)
v_mfma_f32_16x16x32_bf16 v[28:31], v[52:55], v[20:23], v[28:31]
ds_read_b128 v[52:55], v40 offset:12288
s_waitcnt lgkmcnt(4)
v_mfma_f32_16x16x32_bf16 v[32:35], v[56:59], v[8:11], 0
ds_read_b128 v[56:59], v41 offset:12288
s_waitcnt lgkmcnt(4)
v_mfma_f32_16x16x32_bf16 v[32:35], v[60:63], v[12:15], v[32:35]
ds_read_b128 v[60:63], v42 offset:12288
s_waitcnt lgkmcnt(4)
v_mfma_f32_16x16x32_bf16 v[32:35], v[44:47], v[16:19], v[32:35]
ds_read_b128 v[44:47], v43 offset:12288
s_waitcnt lgkmcnt(4)
v_mfma_f32_16x16x32_bf16 v[32:35], v[48:51], v[20:23], v[32:35]
s_waitcnt lgkmcnt(3)
v_mfma_f32_16x16x32_bf16 v[36:39], v[52:55], v[8:11], 0
s_waitcnt lgkmcnt(2)
v_mfma_f32_16x16x32_bf16 v[36:39], v[56:59], v[12:15], v[36:39]
s_waitcnt lgkmcnt(1)
v_mfma_f32_16x16x32_bf16 v[36:39], v[60:63], v[16:19], v[36:39]
s_waitcnt lgkmcnt(0)
v_mfma_f32_16x16x32_bf16 v[36:39], v[44:47], v[20:23], v[36:39]
v_xor_b32 v41, 1024, v0
v_xor_b32 v42, 2048, v0
v_xor_b32 v43, 3072, v0
ds_write_b128 v0, v[24:27] offset:8192
ds_write_b128 v0, v[28:31] offset:12288
ds_write_b128 v0, v[32:35] offset:16384
s_nop 1
ds_write_b128 v0, v[36:39] offset:20480
v_bfe_u32 v61, v0, 6, 3
v_bfe_u32 v62, v0, 9, 1
v_lshl_or_b32 v61, v61, 1, v62
v_bfe_u32 v62, v0, 5, 1
v_xor_b32 v61, v61, v62
v_bfe_u32 v60, v0, 4, 1
v_lshlrev_b32 v60, 3, v60
v_bfe_u32 v47, v0, 6, 4
v_lshl_add_u32 v60, v47, 8, v60
v_bfe_u32 v47, v0, 10, 2
v_lshl_add_u32 v60, v47, 14, v60
v_add_u32 v60, 98304, v60
v_lshl_add_u32 v60, v61, 4, v60
v_bfe_u32 v62, v0, 4, 4
v_lshlrev_b32 v62, 4, v62
v_bfe_u32 v47, v0, 8, 2
v_lshl_add_u32 v62, v47, 12, v62
v_bfe_u32 v47, v0, 10, 2
v_lshl_add_u32 v62, v47, 8, v62
v_bfe_u32 v63, v0, 4, 4
v_lshlrev_b32 v63, 10, v63
s_waitcnt lgkmcnt(0)
s_barrier
ds_read_b128 v[8:11], v41 offset:8192
ds_read_b128 v[12:15], v41 offset:12288
ds_read_b128 v[16:19], v41 offset:16384
ds_read_b128 v[20:23], v41 offset:20480
ds_read_b128 v[44:47], v42 offset:8192
ds_read_b128 v[48:51], v42 offset:12288
ds_read_b128 v[52:55], v42 offset:16384
ds_read_b128 v[56:59], v42 offset:20480
s_waitcnt lgkmcnt(7)
v_pk_add_f32 v[24:25], v[24:25], v[8:9]
v_pk_add_f32 v[26:27], v[26:27], v[10:11]
ds_read_b128 v[8:11], v43 offset:8192
s_waitcnt lgkmcnt(7)
v_pk_add_f32 v[28:29], v[28:29], v[12:13]
v_pk_add_f32 v[30:31], v[30:31], v[14:15]
ds_read_b128 v[12:15], v43 offset:12288
s_waitcnt lgkmcnt(7)
v_pk_add_f32 v[32:33], v[32:33], v[16:17]
v_pk_add_f32 v[34:35], v[34:35], v[18:19]
ds_read_b128 v[16:19], v43 offset:16384
s_waitcnt lgkmcnt(7)
v_pk_add_f32 v[36:37], v[36:37], v[20:21]
v_pk_add_f32 v[38:39], v[38:39], v[22:23]
ds_read_b128 v[20:23], v43 offset:20480
s_waitcnt lgkmcnt(3)
v_pk_add_f32 v[44:45], v[44:45], v[8:9]
v_pk_add_f32 v[46:47], v[46:47], v[10:11]
v_pk_add_f32 v[24:25], v[24:25], v[44:45]
v_pk_add_f32 v[26:27], v[26:27], v[46:47]
s_waitcnt lgkmcnt(2)
v_pk_add_f32 v[48:49], v[48:49], v[12:13]
v_pk_add_f32 v[50:51], v[50:51], v[14:15]
v_pk_add_f32 v[28:29], v[28:29], v[48:49]
v_pk_add_f32 v[30:31], v[30:31], v[50:51]
s_waitcnt lgkmcnt(1)
v_pk_add_f32 v[52:53], v[52:53], v[16:17]
v_pk_add_f32 v[54:55], v[54:55], v[18:19]
v_pk_add_f32 v[32:33], v[32:33], v[52:53]
v_pk_add_f32 v[34:35], v[34:35], v[54:55]
s_waitcnt lgkmcnt(0)
v_pk_add_f32 v[56:57], v[56:57], v[20:21]
v_pk_add_f32 v[58:59], v[58:59], v[22:23]
v_pk_add_f32 v[36:37], v[36:37], v[56:57]
v_pk_add_f32 v[38:39], v[38:39], v[58:59]
v_max3_f32 v40, v24, v25, v26
v_max3_f32 v41, v27, v28, v29
v_max3_f32 v40, v40, v30, v31
v_max3_f32 v41, v41, v32, v33
v_max3_f32 v40, v40, v34, v35
v_max3_f32 v41, v41, v36, v37
v_max3_f32 v40, v40, v38, v39
v_max_f32 v40, v40, v41
v_xor_b32 v61, 0, v60
ds_read_b64_tr_b16 v[48:49], v61 offset:0
ds_read_b64_tr_b16 v[50:51], v61 offset:4096
ds_read_b64_tr_b16 v[52:53], v61 offset:8192
ds_read_b64_tr_b16 v[54:55], v61 offset:12288
v_xor_b32 v61, 32, v60
ds_read_b64_tr_b16 v[56:57], v61 offset:0
ds_read_b64_tr_b16 v[58:59], v61 offset:4096
v_mov_b32 v41, v40
s_nop 1
v_permlane16_swap_b32 v40, v41
v_max_f32 v40, v40, v41
v_mov_b32 v41, v40
s_nop 1
v_permlane32_swap_b32 v40, v41
v_max_f32 v40, v40, v41
v_mul_f32 v40, s82, v40
v_fma_f32 v24, v24, s82, -v40
v_fma_f32 v25, v25, s82, -v40
v_fma_f32 v26, v26, s82, -v40
v_fma_f32 v27, v27, s82, -v40
v_fma_f32 v28, v28, s82, -v40
v_fma_f32 v29, v29, s82, -v40
v_fma_f32 v30, v30, s82, -v40
v_fma_f32 v31, v31, s82, -v40
v_fma_f32 v32, v32, s82, -v40
v_fma_f32 v33, v33, s82, -v40
v_fma_f32 v34, v34, s82, -v40
v_fma_f32 v35, v35, s82, -v40
v_fma_f32 v36, v36, s82, -v40
v_fma_f32 v37, v37, s82, -v40
v_fma_f32 v38, v38, s82, -v40
v_fma_f32 v39, v39, s82, -v40
v_exp_f32 v24, v24
v_exp_f32 v25, v25
v_exp_f32 v26, v26
v_exp_f32 v27, v27
v_exp_f32 v28, v28
v_exp_f32 v29, v29
v_exp_f32 v30, v30
v_exp_f32 v31, v31
v_exp_f32 v32, v32
v_exp_f32 v33, v33
v_exp_f32 v34, v34
v_exp_f32 v35, v35
v_exp_f32 v36, v36
v_exp_f32 v37, v37
v_exp_f32 v38, v38
v_exp_f32 v39, v39
v_cvt_pk_bf16_f32 v8, v24, v25
v_cvt_pk_bf16_f32 v9, v26, v27
v_cvt_pk_bf16_f32 v10, v28, v29
v_cvt_pk_bf16_f32 v11, v30, v31
v_cvt_pk_bf16_f32 v12, v32, v33
v_cvt_pk_bf16_f32 v13, v34, v35
v_cvt_pk_bf16_f32 v14, v36, v37
v_cvt_pk_bf16_f32 v15, v38, v39
s_waitcnt lgkmcnt(4)
v_mfma_f32_16x16x32_bf16 v[16:19], v[8:11], v[48:51], 0
ds_read_b64_tr_b16 v[48:49], v61 offset:8192
ds_read_b64_tr_b16 v[50:51], v61 offset:12288
v_pk_add_f32 v[32:33], v[32:33], v[24:25]
v_pk_add_f32 v[34:35], v[34:35], v[26:27]
s_waitcnt lgkmcnt(4)
v_mfma_f32_16x16x32_bf16 v[16:19], v[12:15], v[52:55], v[16:19]
v_xor_b32 v61, 64, v60
ds_read_b64_tr_b16 v[52:53], v61 offset:0
ds_read_b64_tr_b16 v[54:55], v61 offset:4096
v_pk_add_f32 v[36:37], v[36:37], v[28:29]
v_pk_add_f32 v[38:39], v[38:39], v[30:31]
s_waitcnt lgkmcnt(4)
v_mfma_f32_16x16x32_bf16 v[20:23], v[8:11], v[56:59], 0
ds_read_b64_tr_b16 v[56:57], v61 offset:8192
ds_read_b64_tr_b16 v[58:59], v61 offset:12288
v_pk_add_f32 v[32:33], v[32:33], v[36:37]
v_pk_add_f32 v[34:35], v[34:35], v[38:39]
s_waitcnt lgkmcnt(4)
v_mfma_f32_16x16x32_bf16 v[20:23], v[12:15], v[48:51], v[20:23]
v_xor_b32 v61, 96, v60
ds_read_b64_tr_b16 v[48:49], v61 offset:0
ds_read_b64_tr_b16 v[50:51], v61 offset:4096
v_pk_add_f32 v[32:33], v[32:33], v[34:35]
v_add_f32 v41, v32, v33
s_waitcnt lgkmcnt(4)
v_mfma_f32_16x16x32_bf16 v[24:27], v[8:11], v[52:55], 0
ds_read_b64_tr_b16 v[52:53], v61 offset:8192
ds_read_b64_tr_b16 v[54:55], v61 offset:12288
v_mov_b32 v42, v41
s_nop 1
v_permlane16_swap_b32 v41, v42
v_add_f32 v41, v41, v42
v_mov_b32 v42, v41
s_nop 1
v_permlane32_swap_b32 v41, v42
v_add_f32 v41, v41, v42
s_waitcnt lgkmcnt(4)
v_mfma_f32_16x16x32_bf16 v[24:27], v[12:15], v[56:59], v[24:27]
v_xor_b32 v61, 128, v60
ds_read_b64_tr_b16 v[56:57], v61 offset:0
ds_read_b64_tr_b16 v[58:59], v61 offset:4096
s_cmp_lg_u32 s62, 0
s_cbranch_scc1 S_39
s_mov_b64 exec, 0xffff
buffer_store_dwordx2 v[40:41], v63, s[16:19], s100 offen sc1
s_mov_b64 exec, -1
S_39:
s_waitcnt lgkmcnt(4)
v_mfma_f32_16x16x32_bf16 v[28:31], v[8:11], v[48:51], 0
ds_read_b64_tr_b16 v[48:49], v61 offset:8192
ds_read_b64_tr_b16 v[50:51], v61 offset:12288
s_waitcnt lgkmcnt(4)
v_mfma_f32_16x16x32_bf16 v[28:31], v[12:15], v[52:55], v[28:31]
v_xor_b32 v61, 160, v60
ds_read_b64_tr_b16 v[52:53], v61 offset:0
ds_read_b64_tr_b16 v[54:55], v61 offset:4096
v_cvt_pk_bf16_f32 v32, v16, v20
v_cvt_pk_bf16_f32 v36, v17, v21
v_cvt_pk_bf16_f32 v40, v18, v22
v_cvt_pk_bf16_f32 v44, v19, v23
s_waitcnt lgkmcnt(4)
v_mfma_f32_16x16x32_bf16 v[16:19], v[8:11], v[56:59], 0
ds_read_b64_tr_b16 v[56:57], v61 offset:8192
ds_read_b64_tr_b16 v[58:59], v61 offset:12288
s_waitcnt lgkmcnt(4)
v_mfma_f32_16x16x32_bf16 v[16:19], v[12:15], v[48:51], v[16:19]
v_xor_b32 v61, 192, v60
ds_read_b64_tr_b16 v[48:49], v61 offset:0
ds_read_b64_tr_b16 v[50:51], v61 offset:4096
s_waitcnt lgkmcnt(4)
v_mfma_f32_16x16x32_bf16 v[20:23], v[8:11], v[52:55], 0
ds_read_b64_tr_b16 v[52:53], v61 offset:8192
ds_read_b64_tr_b16 v[54:55], v61 offset:12288
s_waitcnt lgkmcnt(4)
v_mfma_f32_16x16x32_bf16 v[20:23], v[12:15], v[56:59], v[20:23]
v_xor_b32 v61, 224, v60
ds_read_b64_tr_b16 v[56:57], v61 offset:0
ds_read_b64_tr_b16 v[58:59], v61 offset:4096
v_cvt_pk_bf16_f32 v33, v24, v28
v_cvt_pk_bf16_f32 v37, v25, v29
v_cvt_pk_bf16_f32 v41, v26, v30
v_cvt_pk_bf16_f32 v45, v27, v31
s_waitcnt lgkmcnt(4)
v_mfma_f32_16x16x32_bf16 v[24:27], v[8:11], v[48:51], 0
ds_read_b64_tr_b16 v[48:49], v61 offset:8192
ds_read_b64_tr_b16 v[50:51], v61 offset:12288
s_waitcnt lgkmcnt(4)
v_mfma_f32_16x16x32_bf16 v[24:27], v[12:15], v[52:55], v[24:27]
s_waitcnt lgkmcnt(2)
v_mfma_f32_16x16x32_bf16 v[28:31], v[8:11], v[56:59], 0
s_waitcnt lgkmcnt(0)
v_mfma_f32_16x16x32_bf16 v[28:31], v[12:15], v[48:51], v[28:31]
v_cvt_pk_bf16_f32 v34, v16, v20
v_cvt_pk_bf16_f32 v38, v17, v21
v_cvt_pk_bf16_f32 v42, v18, v22
v_cvt_pk_bf16_f32 v46, v19, v23
s_nop 3
v_cvt_pk_bf16_f32 v35, v24, v28
buffer_store_dwordx4 v[32:35], v62, s[16:19], s4 offen offset:0 sc1
v_cvt_pk_bf16_f32 v39, v25, v29
buffer_store_dwordx4 v[36:39], v62, s[16:19], s4 offen offset:1024 sc1
v_cvt_pk_bf16_f32 v43, v26, v30
buffer_store_dwordx4 v[40:43], v62, s[16:19], s4 offen offset:2048 sc1
v_cvt_pk_bf16_f32 v47, v27, v31
buffer_store_dwordx4 v[44:47], v62, s[16:19], s4 offen offset:3072 sc1
v_bfe_u32 v31, v0, 4, 4
v_lshlrev_b32 v31, 4, v31
v_bfe_u32 v47, v0, 8, 1
v_lshl_add_u32 v31, v47, 19, v31
v_bfe_u32 v47, v0, 9, 3
v_lshl_add_u32 v31, v47, 13, v31
s_mov_b32 s5, 0
buffer_load_dwordx4 v[48:51], v31, s[36:39], s5 offen
s_mov_b32 s5, 131072
buffer_load_dwordx4 v[52:55], v31, s[36:39], s5 offen
s_mov_b32 s5, 262144
buffer_load_dwordx4 v[56:59], v31, s[36:39], s5 offen
s_mov_b32 s5, 393216
buffer_load_dwordx4 v[60:63], v31, s[36:39], s5 offen
v_bfe_u32 v40, v0, 4, 3
v_lshlrev_b32 v40, 4, v40
v_bfe_u32 v47, v0, 7, 5
v_lshl_add_u32 v40, v47, 17, v40
v_bfe_u32 v41, v0, 7, 5
v_lshlrev_b32 v41, 5, v41
v_add_u32 v42, 32768, v40
s_mov_b32 s100, 4194304
s_bfe_u32 s3, s93, 524288
s_mul_i32 s3, s3, 128
s_add_u32 s100, s100, s3
s_add_u32 s101, s100, 65536
s_mov_b32 s81, 1921024
s_bfe_u32 s3, s60, 327680
s_mul_i32 s3, s3, 1024
s_add_u32 s81, s81, s3
v_bfe_u32 v45, v0, 4, 3
v_lshlrev_b32 v45, 5, v45
v_bfe_u32 v47, v0, 8, 1
v_lshl_add_u32 v45, v47, 4, v45
v_bfe_u32 v47, v0, 9, 3
v_lshl_add_u32 v45, v47, 8, v45
v_add_u32 v45, 4096, v45
v_bfe_u32 v46, v0, 4, 4
v_lshlrev_b32 v46, 3, v46
v_bfe_u32 v47, v0, 8, 4
v_lshl_add_u32 v46, v47, 13, v46
s_sleep 20
s_mov_b32 s80, 0
buffer_load_dwordx4 v[24:27], v41, s[16:19], s81 offen offset:0 sc1
buffer_load_dwordx4 v[28:31], v41, s[16:19], s81 offen offset:16 sc1
buffer_load_dwordx4 v[8:11], v40, s[16:19], s100 offen sc1
buffer_load_dwordx4 v[12:15], v42, s[16:19], s100 offen sc1
buffer_load_dwordx4 v[16:19], v40, s[16:19], s101 offen sc1
buffer_load_dwordx4 v[20:23], v42, s[16:19], s101 offen sc1
s_waitcnt vmcnt(0)
P_40:
v_max3_u32 v44, v8, v9, v31
v_max3_u32 v44, v44, v10, v11
v_max3_u32 v44, v44, v12, v13
v_max3_u32 v44, v44, v14, v15
v_max3_u32 v44, v44, v16, v17
v_max3_u32 v44, v44, v18, v19
v_max3_u32 v44, v44, v20, v21
v_max3_u32 v44, v44, v22, v23
v_max3_u32 v44, v44, v24, v25
v_max3_u32 v44, v44, v26, v27
v_max3_u32 v44, v44, v28, v29
v_max3_u32 v44, v44, v30, v31
v_cmp_eq_u32 vcc, -1, v44
s_nop 0
s_cbranch_vccnz R_42
D_41:
v_max3_f32 v44, v24, v26, v28
v_max_f32 v44, v44, v30
s_nop 1
v_max_f32_dpp v44, v44, v44 row_ror:8 row_mask:0xf bank_mask:0xf
v_mov_b32 v43, v44
s_nop 1
v_permlane16_swap_b32 v44, v43
v_max_f32 v44, v44, v43
v_mov_b32 v43, v44
s_nop 1
v_permlane32_swap_b32 v44, v43
v_max_f32 v44, v44, v43
v_sub_f32 v24, v24, v44
v_sub_f32 v26, v26, v44
v_sub_f32 v28, v28, v44
v_sub_f32 v30, v30, v44
v_exp_f32 v24, v24
v_exp_f32 v26, v26
v_exp_f32 v28, v28
v_exp_f32 v30, v30
v_cvt_pk_bf16_f32 v24, v24, v26
v_cvt_pk_bf16_f32 v26, v28, v30
v_perm_b32 v47, v24, v24, v1
v_cndmask_b32 v32, 0, v47, s[64:65]
v_cndmask_b32 v33, 0, v47, s[66:67]
v_cndmask_b32 v34, 0, v47, s[68:69]
v_cndmask_b32 v35, 0, v47, s[70:71]
v_perm_b32 v47, v24, v24, v2
v_cndmask_b32 v36, 0, v47, s[64:65]
v_cndmask_b32 v37, 0, v47, s[66:67]
v_cndmask_b32 v38, 0, v47, s[68:69]
v_cndmask_b32 v39, 0, v47, s[70:71]
v_mfma_f32_16x16x32_bf16 v[40:43], v[32:35], v[8:11], 0
v_perm_b32 v47, v26, v26, v1
v_cndmask_b32 v32, 0, v47, s[64:65]
v_cndmask_b32 v33, 0, v47, s[66:67]
v_cndmask_b32 v34, 0, v47, s[68:69]
v_cndmask_b32 v35, 0, v47, s[70:71]
v_mfma_f32_16x16x32_bf16 v[40:43], v[36:39], v[12:15], v[40:43]
v_perm_b32 v47, v26, v26, v2
v_cndmask_b32 v36, 0, v47, s[64:65]
v_cndmask_b32 v37, 0, v47, s[66:67]
v_cndmask_b32 v38, 0, v47, s[68:69]
v_cndmask_b32 v39, 0, v47, s[70:71]
v_mfma_f32_16x16x32_bf16 v[40:43], v[32:35], v[16:19], v[40:43]
s_nop 0
v_mfma_f32_16x16x32_bf16 v[40:43], v[36:39], v[20:23], v[40:43]
v_lshlrev_b32 v28, 16, v24
v_and_b32 v30, s83, v24
v_mul_f32 v25, v28, v25
v_fmac_f32 v25, v30, v27
v_lshlrev_b32 v28, 16, v26
v_and_b32 v30, s83, v26
v_fmac_f32 v25, v28, v29
v_fmac_f32 v25, v30, v31
s_mov_b32 exec_lo, 0x00ff00ff
s_mov_b32 exec_hi, 0xff00ff00
ds_write_b128 v45, v[40:43]
s_mov_b64 exec, -1
v_add_f32_dpp v25, v25, v25 row_ror:8 row_mask:0xf bank_mask:0xf
v_mov_b32 v28, v25
s_nop 1
v_permlane16_swap_b32 v25, v28
v_add_f32 v25, v25, v28
v_mov_b32 v28, v25
s_nop 1
v_permlane32_swap_b32 v25, v28
v_add_f32 v25, v25, v28
s_lshl_b32 s3, s62, 3
v_mov_b32 v24, v44
v_mov_b32 v28, s3
ds_write_b64 v28, v[24:25] offset:29216
v_bfe_u32 v32, v0, 7, 1
v_lshlrev_b32 v32, 10, v32
v_bfe_u32 v47, v0, 8, 4
v_lshl_add_u32 v32, v47, 4, v32
v_add_u32 v32, 4096, v32
v_bfe_u32 v33, v0, 7, 1
v_lshlrev_b32 v33, 4, v33
s_waitcnt lgkmcnt(0)
s_barrier
ds_read_b128 v[24:27], v33 offset:29216
ds_read_b128 v[8:11], v32 offset:0
ds_read_b128 v[12:15], v32 offset:256
ds_read_b128 v[16:19], v32 offset:512
ds_read_b128 v[20:23], v32 offset:768
v_bfe_u32 v44, v0, 4, 2
v_lshlrev_b32 v44, 8, v44
v_bfe_u32 v47, v0, 6, 2
v_lshl_add_u32 v44, v47, 11, v44
v_bfe_u32 v47, v0, 8, 1
v_lshl_add_u32 v44, v47, 7, v44
v_bfe_u32 v47, v0, 9, 1
v_lshl_add_u32 v44, v47, 6, v44
s_mov_b32 s4, 1986560
s_bfe_u32 s3, s60, 327680
s_mul_i32 s3, s3, 8192
s_add_u32 s4, s4, s3
s_bfe_u32 s3, s61, 65538
s_mul_i32 s3, s3, 1024
s_add_u32 s4, s4, s3
s_bfe_u32 s3, s61, 131072
s_mul_i32 s3, s3, 16
s_add_u32 s4, s4, s3
s_waitcnt lgkmcnt(4)
v_max_f32 v28, v24, v26
v_sub_f32 v24, v24, v28
v_sub_f32 v26, v26, v28
v_exp_f32 v24, v24
v_exp_f32 v26, v26
v_mul_f32 v25, v24, v25
v_fmac_f32 v25, v26, v27
v_rcp_f32 v25, v25
s_waitcnt lgkmcnt(0)
v_pk_add_f32 v[8:9], v[8:9], v[12:13]
v_pk_add_f32 v[16:17], v[16:17], v[20:21]
v_pk_add_f32 v[10:11], v[10:11], v[14:15]
v_pk_add_f32 v[18:19], v[18:19], v[22:23]
v_mul_f32 v24, v24, v25
v_mul_f32 v26, v26, v25
v_mul_f32 v8, v24, v8
v_mul_f32 v9, v24, v9
v_mul_f32 v10, v24, v10
v_mul_f32 v11, v24, v11
v_fmac_f32 v8, v26, v16
v_fmac_f32 v9, v26, v17
v_fmac_f32 v10, v26, v18
v_fmac_f32 v11, v26, v19
v_cvt_pk_bf16_f32 v8, v8, v9
v_cvt_pk_bf16_f32 v9, v10, v11
v_perm_b32 v10, v8, v8, v1
v_cndmask_b32 v12, 0, v10, s[64:65]
v_cndmask_b32 v13, 0, v10, s[66:67]
v_cndmask_b32 v14, 0, v10, s[68:69]
v_cndmask_b32 v15, 0, v10, s[70:71]
v_perm_b32 v10, v8, v8, v2
v_cndmask_b32 v16, 0, v10, s[64:65]
v_cndmask_b32 v17, 0, v10, s[66:67]
v_cndmask_b32 v18, 0, v10, s[68:69]
v_cndmask_b32 v19, 0, v10, s[70:71]
v_mfma_f32_16x16x32_bf16 v[36:39], v[12:15], v[48:51], 0
v_perm_b32 v10, v9, v9, v1
v_cndmask_b32 v20, 0, v10, s[64:65]
v_cndmask_b32 v21, 0, v10, s[66:67]
v_cndmask_b32 v22, 0, v10, s[68:69]
v_cndmask_b32 v23, 0, v10, s[70:71]
v_mfma_f32_16x16x32_bf16 v[36:39], v[16:19], v[52:55], v[36:39]
v_perm_b32 v10, v9, v9, v2
v_cndmask_b32 v24, 0, v10, s[64:65]
v_cndmask_b32 v25, 0, v10, s[66:67]
v_cndmask_b32 v26, 0, v10, s[68:69]
v_cndmask_b32 v27, 0, v10, s[70:71]
v_mfma_f32_16x16x32_bf16 v[36:39], v[20:23], v[56:59], v[36:39]
s_nop 0
v_mfma_f32_16x16x32_bf16 v[36:39], v[24:27], v[60:63], v[36:39]
s_nop 7
ds_write_b128 v0, v[36:39] offset:0
buffer_load_dwordx2 v[48:49], v46, s[40:43], 0 offen offset:0
buffer_load_dwordx2 v[50:51], v46, s[40:43], 0 offen offset:1024
buffer_load_dwordx2 v[52:53], v46, s[40:43], 0 offen offset:2048
buffer_load_dwordx2 v[54:55], v46, s[40:43], 0 offen offset:3072
buffer_load_dwordx2 v[56:57], v46, s[40:43], s90 offen offset:0
buffer_load_dwordx2 v[58:59], v46, s[40:43], s90 offen offset:1024
buffer_load_dwordx2 v[60:61], v46, s[40:43], s90 offen offset:2048
buffer_load_dwordx2 v[62:63], v46, s[40:43], s90 offen offset:3072
s_waitcnt lgkmcnt(0)
s_barrier
s_cmp_lg_u32 s62, 0
s_cbranch_scc1 S_49
ds_read_b128 v[8:11], v0 offset:0
ds_read_b128 v[12:15], v0 offset:1024
ds_read_b128 v[16:19], v0 offset:2048
ds_read_b128 v[20:23], v0 offset:3072
s_waitcnt lgkmcnt(2)
v_pk_add_f32 v[8:9], v[8:9], v[12:13]
v_pk_add_f32 v[10:11], v[10:11], v[14:15]
s_waitcnt lgkmcnt(0)
v_pk_add_f32 v[16:17], v[16:17], v[20:21]
v_pk_add_f32 v[18:19], v[18:19], v[22:23]
v_pk_add_f32 v[8:9], v[8:9], v[16:17]
v_pk_add_f32 v[10:11], v[10:11], v[18:19]
buffer_store_dwordx4 v[8:11], v44, s[8:11], s4 offen
buffer_store_dwordx4 v[8:11], v44, s[16:19], s4 offen sc1
s_mov_b64 exec, -1
S_49:
s_mov_b32 s81, 1986560
s_bfe_u32 s3, s60, 327680
s_mul_i32 s3, s3, 8192
s_add_u32 s81, s81, s3
s_bfe_u32 s3, s62, 131072
s_mul_i32 s3, s3, 1024
s_add_u32 s81, s81, s3
v_bfe_u32 v44, v0, 4, 2
v_lshlrev_b32 v44, 8, v44
v_bfe_u32 v47, v0, 6, 2
v_lshl_add_u32 v44, v47, 12, v44
v_bfe_u32 v47, v0, 8, 1
v_lshl_add_u32 v44, v47, 7, v44
s_mov_b32 s4, 401408
s_bfe_u32 s3, s61, 196608
s_mul_i32 s3, s3, 16384
s_add_u32 s4, s4, s3
s_bfe_u32 s3, s60, 131072
s_mul_i32 s3, s3, 1024
s_add_u32 s4, s4, s3
s_bfe_u32 s3, s60, 196610
s_mul_i32 s3, s3, 16
s_add_u32 s4, s4, s3
v_bfe_u32 v46, v0, 4, 4
v_lshlrev_b32 v46, 4, v46
v_bfe_u32 v47, v0, 8, 4
v_lshl_add_u32 v46, v47, 15, v46
s_barrier
s_sleep 5
s_mov_b32 s80, 0
buffer_load_dwordx4 v[8:11], v0, s[8:11], s81 offen
buffer_load_dwordx4 v[12:15], v0, s[8:11], s81 offen offset:1024
v_bfe_u32 v38, v0, 4, 1
v_lshlrev_b32 v38, 7, v38
v_bfe_u32 v47, v0, 6, 6
v_lshl_add_u32 v38, v47, 13, v38
s_mov_b32 m0, 29440
s_nop 0
buffer_load_dword v38, s[20:23], 0 offen lds
s_waitcnt vmcnt(1)
P_50:
v_max3_u32 v18, v8, v9, v15
v_max3_u32 v18, v18, v10, v11
v_max3_u32 v18, v18, v12, v13
v_max3_u32 v18, v18, v14, v15
v_cmp_eq_u32 vcc, -1, v18
s_nop 0
s_cbranch_vccnz R_52
D_51:
v_pk_add_f32 v[8:9], v[8:9], v[12:13]
v_pk_add_f32 v[10:11], v[10:11], v[14:15]
s_nop 0
v_add_f32_dpp v8, v8, v8 quad_perm:[1,0,3,2] row_mask:0xf bank_mask:0xf
v_add_f32_dpp v9, v9, v9 quad_perm:[1,0,3,2] row_mask:0xf bank_mask:0xf
v_add_f32_dpp v10, v10, v10 quad_perm:[1,0,3,2] row_mask:0xf bank_mask:0xf
v_add_f32_dpp v11, v11, v11 quad_perm:[1,0,3,2] row_mask:0xf bank_mask:0xf
v_add_f32_dpp v8, v8, v8 quad_perm:[2,3,0,1] row_mask:0xf bank_mask:0xf
v_add_f32_dpp v9, v9, v9 quad_perm:[2,3,0,1] row_mask:0xf bank_mask:0xf
v_add_f32_dpp v10, v10, v10 quad_perm:[2,3,0,1] row_mask:0xf bank_mask:0xf
v_add_f32_dpp v11, v11, v11 quad_perm:[2,3,0,1] row_mask:0xf bank_mask:0xf
v_cvt_pk_bf16_f32 v8, v8, v9
v_cvt_pk_bf16_f32 v9, v10, v11
v_perm_b32 v12, v8, v8, v1
v_perm_b32 v13, v8, v8, v2
v_cndmask_b32 v16, 0, v12, s[72:73]
v_cndmask_b32 v17, 0, v12, s[74:75]
v_cndmask_b32 v18, 0, v13, s[72:73]
v_cndmask_b32 v19, 0, v13, s[74:75]
v_perm_b32 v14, v9, v9, v1
v_perm_b32 v15, v9, v9, v2
v_cndmask_b32 v20, 0, v14, s[72:73]
v_cndmask_b32 v21, 0, v14, s[74:75]
v_cndmask_b32 v22, 0, v15, s[72:73]
v_cndmask_b32 v23, 0, v15, s[74:75]
v_mfma_f32_16x16x32_bf16 v[36:39], v[16:19], v[48:51], 0
v_cndmask_b32 v24, 0, v12, s[96:97]
v_cndmask_b32 v25, 0, v12, s[98:99]
v_cndmask_b32 v26, 0, v13, s[96:97]
v_cndmask_b32 v27, 0, v13, s[98:99]
v_mfma_f32_16x16x32_bf16 v[36:39], v[20:23], v[52:55], v[36:39]
v_cndmask_b32 v28, 0, v14, s[96:97]
v_cndmask_b32 v29, 0, v14, s[98:99]
v_cndmask_b32 v30, 0, v15, s[96:97]
v_cndmask_b32 v31, 0, v15, s[98:99]
v_mfma_f32_16x16x32_bf16 v[36:39], v[24:27], v[56:59], v[36:39]
s_nop 0
v_mfma_f32_16x16x32_bf16 v[36:39], v[28:31], v[60:63], v[36:39]
s_nop 7
ds_write_b128 v0, v[36:39] offset:4096
buffer_load_dwordx4 v[48:51], v46, s[20:23], s86 offen
buffer_load_dwordx4 v[52:55], v46, s[20:23], s87 offen
buffer_load_dwordx4 v[56:59], v46, s[20:23], s88 offen
buffer_load_dwordx4 v[60:63], v46, s[20:23], s89 offen
s_waitcnt lgkmcnt(0)
s_barrier
s_cmp_lg_u32 s62, 0
s_cbranch_scc1 S_56
ds_read_b128 v[8:11], v0 offset:4096
ds_read_b128 v[12:15], v0 offset:4608
ds_read_b128 v[16:19], v0 offset:5120
ds_read_b128 v[20:23], v0 offset:5632
ds_read_b128 v[24:27], v0 offset:6144
ds_read_b128 v[28:31], v0 offset:6656
ds_read_b128 v[32:35], v0 offset:7168
ds_read_b128 v[36:39], v0 offset:7680
s_waitcnt lgkmcnt(6)
v_pk_add_f32 v[8:9], v[8:9], v[12:13]
v_pk_add_f32 v[10:11], v[10:11], v[14:15]
s_waitcnt lgkmcnt(4)
v_pk_add_f32 v[16:17], v[16:17], v[20:21]
v_pk_add_f32 v[18:19], v[18:19], v[22:23]
s_waitcnt lgkmcnt(2)
v_pk_add_f32 v[24:25], v[24:25], v[28:29]
v_pk_add_f32 v[26:27], v[26:27], v[30:31]
s_waitcnt lgkmcnt(0)
v_pk_add_f32 v[32:33], v[32:33], v[36:37]
v_pk_add_f32 v[34:35], v[34:35], v[38:39]
v_pk_add_f32 v[8:9], v[8:9], v[16:17]
v_pk_add_f32 v[10:11], v[10:11], v[18:19]
v_pk_add_f32 v[24:25], v[24:25], v[32:33]
v_pk_add_f32 v[26:27], v[26:27], v[34:35]
v_pk_add_f32 v[8:9], v[8:9], v[24:25]
v_pk_add_f32 v[10:11], v[10:11], v[26:27]
s_mov_b32 exec_lo, -1
s_mov_b32 exec_hi, 0
buffer_store_dwordx4 v[8:11], v44, s[16:19], s4 offen sc1
s_mov_b64 exec, -1
S_56:
s_nop 0
v_bfe_u32 v44, v0, 4, 4
v_lshlrev_b32 v44, 8, v44
v_bfe_u32 v47, v0, 8, 1
v_lshl_add_u32 v44, v47, 7, v44
v_bfe_u32 v47, v0, 9, 1
v_lshl_add_u32 v44, v47, 6, v44
s_mov_b32 s4, 1060864
s_bfe_u32 s3, s60, 327680
s_mul_i32 s3, s3, 8320
s_add_u32 s4, s4, s3
s_bfe_u32 s3, s61, 65538
s_mul_i32 s3, s3, 4096
s_add_u32 s4, s4, s3
s_bfe_u32 s3, s61, 131072
s_mul_i32 s3, s3, 16
s_add_u32 s4, s4, s3
s_mov_b32 s100, 1069056
s_bfe_u32 s3, s60, 327680
s_mul_i32 s3, s3, 8320
s_add_u32 s100, s100, s3
s_bfe_u32 s3, s61, 196608
s_mul_i32 s3, s3, 16
s_add_u32 s100, s100, s3
v_bfe_u32 v45, v0, 9, 1
v_lshlrev_b32 v45, 3, v45
v_mov_b32 v28, 0x3f803f80
v_mov_b32 v29, v28
v_mov_b32 v30, v28
v_mov_b32 v31, v28
s_mov_b32 s81, 401408
s_bfe_u32 s3, s61, 196608
s_mul_i32 s3, s3, 16384
s_add_u32 s81, s81, s3
s_bfe_u32 s3, s62, 131072
s_mul_i32 s3, s3, 3072
s_add_u32 s81, s81, s3
s_barrier
s_sleep 22
s_mov_b32 s80, 0
buffer_load_dwordx4 v[8:11], v0, s[16:19], s81 offen offset:0 sc1
buffer_load_dwordx4 v[12:15], v0, s[16:19], s81 offen offset:1024 sc1
buffer_load_dwordx4 v[16:19], v0, s[16:19], s81 offen offset:2048 sc1
buffer_load_dwordx4 v[20:23], v0, s[16:19], s81 offen offset:3072 sc1
v_bfe_u32 v38, v0, 5, 7
v_lshlrev_b32 v38, 10, v38
s_mov_b32 m0, 29440
s_nop 0
buffer_load_dword v38, s[24:27], 0 offen lds
s_waitcnt vmcnt(1)
P_57:
v_max3_u32 v24, v8, v9, v23
v_max3_u32 v24, v24, v10, v11
v_max3_u32 v24, v24, v12, v13
v_max3_u32 v24, v24, v14, v15
v_max3_u32 v24, v24, v16, v17
v_max3_u32 v24, v24, v18, v19
v_max3_u32 v24, v24, v20, v21
v_max3_u32 v24, v24, v22, v23
v_cmp_eq_u32 vcc, -1, v24
s_nop 0
s_cbranch_vccnz R_59
D_58:
v_pk_add_f32 v[8:9], v[8:9], v[12:13]
v_pk_add_f32 v[16:17], v[16:17], v[20:21]
v_pk_add_f32 v[10:11], v[10:11], v[14:15]
v_pk_add_f32 v[18:19], v[18:19], v[22:23]
v_pk_add_f32 v[8:9], v[8:9], v[16:17]
v_pk_add_f32 v[10:11], v[10:11], v[18:19]
s_nop 0
v_add_f32_dpp v8, v8, v8 quad_perm:[1,0,3,2] row_mask:0xf bank_mask:0xf
v_add_f32_dpp v9, v9, v9 quad_perm:[1,0,3,2] row_mask:0xf bank_mask:0xf
v_add_f32_dpp v10, v10, v10 quad_perm:[1,0,3,2] row_mask:0xf bank_mask:0xf
v_add_f32_dpp v11, v11, v11 quad_perm:[1,0,3,2] row_mask:0xf bank_mask:0xf
v_add_f32_dpp v8, v8, v8 quad_perm:[2,3,0,1] row_mask:0xf bank_mask:0xf
v_add_f32_dpp v9, v9, v9 quad_perm:[2,3,0,1] row_mask:0xf bank_mask:0xf
v_add_f32_dpp v10, v10, v10 quad_perm:[2,3,0,1] row_mask:0xf bank_mask:0xf
v_add_f32_dpp v11, v11, v11 quad_perm:[2,3,0,1] row_mask:0xf bank_mask:0xf
v_add_f32_dpp v8, v8, v8 row_half_mirror row_mask:0xf bank_mask:0xf
v_add_f32_dpp v9, v9, v9 row_half_mirror row_mask:0xf bank_mask:0xf
v_add_f32_dpp v10, v10, v10 row_half_mirror row_mask:0xf bank_mask:0xf
v_add_f32_dpp v11, v11, v11 row_half_mirror row_mask:0xf bank_mask:0xf
v_cvt_pk_bf16_f32 v8, v8, v9
v_cvt_pk_bf16_f32 v9, v10, v11
v_lshlrev_b32 v10, 16, v8
v_and_b32 v11, s83, v8
v_lshlrev_b32 v12, 16, v9
v_and_b32 v13, s83, v9
v_pk_add_f32 v[4:5], v[4:5], v[10:11]
v_pk_add_f32 v[6:7], v[6:7], v[12:13]
v_cvt_pk_bf16_f32 v8, v4, v5
v_cvt_pk_bf16_f32 v9, v6, v7
v_perm_b32 v10, v8, v8, v1
v_cndmask_b32 v12, 0, v10, s[64:65]
v_cndmask_b32 v13, 0, v10, s[66:67]
v_cndmask_b32 v14, 0, v10, s[68:69]
v_cndmask_b32 v15, 0, v10, s[70:71]
v_perm_b32 v10, v8, v8, v2
v_cndmask_b32 v16, 0, v10, s[64:65]
v_cndmask_b32 v17, 0, v10, s[66:67]
v_cndmask_b32 v18, 0, v10, s[68:69]
v_cndmask_b32 v19, 0, v10, s[70:71]
v_mfma_f32_16x16x32_bf16 v[36:39], v[12:15], v[48:51], 0
v_mfma_f32_16x16x32_bf16 v[40:43], v[12:15], v[28:31], 0
v_mfma_f32_16x16x32_bf16 v[32:35], v[12:15], v[12:15], 0
v_perm_b32 v10, v9, v9, v1
v_cndmask_b32 v20, 0, v10, s[64:65]
v_cndmask_b32 v21, 0, v10, s[66:67]
v_cndmask_b32 v22, 0, v10, s[68:69]
v_cndmask_b32 v23, 0, v10, s[70:71]
v_mfma_f32_16x16x32_bf16 v[36:39], v[16:19], v[52:55], v[36:39]
v_mfma_f32_16x16x32_bf16 v[40:43], v[16:19], v[28:31], v[40:43]
v_mfma_f32_16x16x32_bf16 v[32:35], v[16:19], v[16:19], v[32:35]
v_perm_b32 v10, v9, v9, v2
v_cndmask_b32 v24, 0, v10, s[64:65]
v_cndmask_b32 v25, 0, v10, s[66:67]
v_cndmask_b32 v26, 0, v10, s[68:69]
v_cndmask_b32 v27, 0, v10, s[70:71]
v_mfma_f32_16x16x32_bf16 v[36:39], v[20:23], v[56:59], v[36:39]
v_mfma_f32_16x16x32_bf16 v[40:43], v[20:23], v[28:31], v[40:43]
v_mfma_f32_16x16x32_bf16 v[32:35], v[20:23], v[20:23], v[32:35]
v_mfma_f32_16x16x32_bf16 v[36:39], v[24:27], v[60:63], v[36:39]
v_mfma_f32_16x16x32_bf16 v[40:43], v[24:27], v[28:31], v[40:43]
v_mfma_f32_16x16x32_bf16 v[32:35], v[24:27], v[24:27], v[32:35]
v_lshlrev_b32 v4, 16, v8
v_and_b32 v5, s83, v8
v_lshlrev_b32 v6, 16, v9
v_and_b32 v7, s83, v9
s_nop 1
ds_write_b128 v0, v[36:39] offset:0
s_nop 0
v_mov_b32 v41, v32
ds_write_b64 v0, v[40:41] offset:24576
s_waitcnt lgkmcnt(0)
s_barrier
s_cmp_lg_u32 s62, 0
s_cbranch_scc1 S_64
ds_read_b128 v[8:11], v0 offset:0
ds_read_b128 v[12:15], v0 offset:1024
ds_read_b128 v[16:19], v0 offset:2048
ds_read_b128 v[20:23], v0 offset:3072
s_waitcnt lgkmcnt(2)
v_pk_add_f32 v[8:9], v[8:9], v[12:13]
v_pk_add_f32 v[10:11], v[10:11], v[14:15]
s_waitcnt lgkmcnt(0)
v_pk_add_f32 v[16:17], v[16:17], v[20:21]
v_pk_add_f32 v[18:19], v[18:19], v[22:23]
v_pk_add_f32 v[8:9], v[8:9], v[16:17]
v_pk_add_f32 v[10:11], v[10:11], v[18:19]
buffer_store_dwordx4 v[8:11], v44, s[8:11], s4 offen
buffer_store_dwordx4 v[8:11], v44, s[16:19], s4 offen sc1
s_mov_b64 exec, -1
S_64:
s_cmp_lg_u32 s62, 2
s_cbranch_scc1 S_65
ds_read_b64 v[8:9], v0 offset:22528
ds_read_b64 v[12:13], v0 offset:23552
ds_read_b64 v[16:17], v0 offset:24576
ds_read_b64 v[20:21], v0 offset:25600
s_waitcnt lgkmcnt(2)
v_pk_add_f32 v[8:9], v[8:9], v[12:13]
s_waitcnt lgkmcnt(0)
v_pk_add_f32 v[16:17], v[16:17], v[20:21]
v_pk_add_f32 v[8:9], v[8:9], v[16:17]
s_mov_b32 exec_lo, 1
s_mov_b32 exec_hi, 256
buffer_store_dwordx2 v[8:9], v45, s[8:11], s100 offen
buffer_store_dwordx2 v[8:9], v45, s[16:19], s100 offen sc1
s_mov_b64 exec, -1
S_65:
v_bfe_u32 v41, v0, 4, 2
v_lshlrev_b32 v41, 4, v41
v_bfe_u32 v47, v0, 6, 1
v_lshl_add_u32 v41, v47, 3, v41
v_add_u32 v41, 8192, v41
s_mov_b32 s81, 1060864
s_bfe_u32 s3, s60, 327680
s_mul_i32 s3, s3, 8320
s_add_u32 s81, s81, s3
s_add_u32 s100, s81, 4096
v_bfe_u32 v42, v0, 6, 1
v_lshlrev_b32 v42, 8, v42
v_bfe_u32 v47, v0, 7, 5
v_lshl_add_u32 v42, v47, 3, v42
v_add_u32 v42, 28672, v42
v_bfe_u32 v39, v0, 7, 5
v_lshlrev_b32 v39, 4, v39
v_add_u32 v39, 29696, v39
v_bfe_u32 v43, v0, 4, 2
v_lshlrev_b32 v43, 4, v43
v_bfe_u32 v47, v0, 8, 2
v_lshl_add_u32 v43, v47, 6, v43
v_add_u32 v43, 28672, v43
s_lshl_b32 s3, s63, 8
v_add_u32 v43, s3, v43
v_bfe_u32 v45, v0, 4, 4
v_lshlrev_b32 v45, 5, v45
v_bfe_u32 v47, v0, 8, 2
v_lshl_add_u32 v45, v47, 3, v45
v_bfe_u32 v47, v0, 10, 2
v_lshl_add_u32 v45, v47, 9, v45
v_add_u32 v45, 30720, v45
v_bfe_u32 v46, v0, 8, 2
v_lshlrev_b32 v46, 4, v46
v_bfe_u32 v47, v0, 10, 2
v_lshl_add_u32 v46, v47, 9, v46
v_add_u32 v46, 30720, v46
v_bfe_u32 v44, v0, 4, 6
v_lshlrev_b32 v44, 4, v44
v_bfe_u32 v47, v0, 10, 2
v_lshl_add_u32 v44, v47, 14, v44
v_add_u32 v44, 32768, v44
ds_read_b128 v[20:23], v39
s_barrier
s_sleep 7
s_mov_b32 s80, 0
buffer_load_dwordx2 v[16:17], v41, s[8:11], s81 offen
buffer_load_dwordx2 v[18:19], v41, s[8:11], s81 offen offset:64
buffer_load_dwordx4 v[8:11], v0, s[8:11], s81 offen
buffer_load_dwordx4 v[12:15], v0, s[8:11], s100 offen
s_waitcnt vmcnt(0)
P_66:
v_max3_u32 v30, v8, v9, v19
v_max3_u32 v30, v30, v10, v11
v_max3_u32 v30, v30, v12, v13
v_max3_u32 v30, v30, v14, v15
v_max3_u32 v30, v30, v16, v17
v_max3_u32 v30, v30, v18, v19
v_cmp_eq_u32 vcc, -1, v30
s_nop 0
s_cbranch_vccnz R_68
D_67:
v_bfe_u32 v38, v0, 4, 4
v_lshlrev_b32 v38, 3, v38
v_bfe_u32 v47, v0, 8, 4
v_lshl_add_u32 v38, v47, 13, v38
buffer_load_dwordx2 v[48:49], v38, s[24:27], 0 offen offset:0
buffer_load_dwordx2 v[50:51], v38, s[24:27], 0 offen offset:1024
buffer_load_dwordx2 v[52:53], v38, s[24:27], 0 offen offset:2048
buffer_load_dwordx2 v[54:55], v38, s[24:27], 0 offen offset:3072
buffer_load_dwordx2 v[56:57], v38, s[24:27], s90 offen offset:0
buffer_load_dwordx2 v[58:59], v38, s[24:27], s90 offen offset:1024
buffer_load_dwordx2 v[60:61], v38, s[24:27], s90 offen offset:2048
buffer_load_dwordx2 v[62:63], v38, s[24:27], s90 offen offset:3072
v_bfe_u32 v36, v0, 4, 3
v_lshlrev_b32 v36, 4, v36
v_bfe_u32 v47, v0, 7, 5
v_lshl_add_u32 v36, v47, 15, v36
s_lshl_b32 s3, s93, 7
s_add_u32 s3, s3, 8388608
v_mov_b32 v32, -1
v_mov_b32 v33, -1
v_mov_b32 v34, -1
v_mov_b32 v35, -1
buffer_store_dwordx4 v[32:35], v36, s[16:19], s3 offen sc1
s_add_u32 s3, s3, 1048576
buffer_store_dwordx4 v[32:35], v36, s[16:19], s3 offen sc1
s_add_u32 s3, s3, 1048576
buffer_store_dwordx4 v[32:35], v36, s[16:19], s3 offen sc1
s_add_u32 s3, s3, 1048576
buffer_store_dwordx4 v[32:35], v36, s[16:19], s3 offen sc1
s_add_u32 s3, s3, 1048576
v_pk_add_f32 v[16:17], v[16:17], v[18:19]
v_pk_add_f32 v[8:9], v[8:9], v[12:13]
v_pk_add_f32 v[10:11], v[10:11], v[14:15]
v_add_f32_dpp v16, v16, v16 quad_perm:[1,0,3,2] row_mask:0xf bank_mask:0xf
v_add_f32_dpp v17, v17, v17 quad_perm:[1,0,3,2] row_mask:0xf bank_mask:0xf
v_add_f32_dpp v8, v8, v8 quad_perm:[1,0,3,2] row_mask:0xf bank_mask:0xf
v_add_f32_dpp v9, v9, v9 quad_perm:[1,0,3,2] row_mask:0xf bank_mask:0xf
v_add_f32_dpp v10, v10, v10 quad_perm:[1,0,3,2] row_mask:0xf bank_mask:0xf
v_add_f32_dpp v11, v11, v11 quad_perm:[1,0,3,2] row_mask:0xf bank_mask:0xf
v_add_f32_dpp v16, v16, v16 quad_perm:[2,3,0,1] row_mask:0xf bank_mask:0xf
v_add_f32_dpp v17, v17, v17 quad_perm:[2,3,0,1] row_mask:0xf bank_mask:0xf
v_add_f32_dpp v8, v8, v8 quad_perm:[2,3,0,1] row_mask:0xf bank_mask:0xf
v_add_f32_dpp v9, v9, v9 quad_perm:[2,3,0,1] row_mask:0xf bank_mask:0xf
v_add_f32_dpp v10, v10, v10 quad_perm:[2,3,0,1] row_mask:0xf bank_mask:0xf
v_add_f32_dpp v11, v11, v11 quad_perm:[2,3,0,1] row_mask:0xf bank_mask:0xf
v_mul_f32 v16, s91, v16
v_mul_f32 v17, s91, v17
v_fma_f32 v17, -v16, v16, v17
v_max_f32 v17, 0, v17
v_add_f32 v17, s92, v17
v_rsq_f32 v17, v17
s_waitcnt lgkmcnt(0)
v_fma_f32 v8, -v16, v20, v8
v_fma_f32 v9, -v16, v21, v9
v_fma_f32 v10, -v16, v22, v10
v_fma_f32 v11, -v16, v23, v11
v_mul_f32 v8, v17, v8
v_mul_f32 v9, v17, v9
v_mul_f32 v10, v17, v10
v_mul_f32 v11, v17, v11
v_cvt_pk_bf16_f32 v8, v8, v9
v_cvt_pk_bf16_f32 v9, v10, v11
ds_write_b64 v42, v[8:9]
s_waitcnt lgkmcnt(0)
s_barrier
ds_read_b128 v[40:43], v43
s_waitcnt lgkmcnt(0)
s_mov_b32 s76, 983055
s_mov_b32 s77, 983055
v_cndmask_b32 v8, 0, v40, s[76:77]
v_cndmask_b32 v9, 0, v41, s[76:77]
v_cndmask_b32 v10, 0, v42, s[76:77]
v_cndmask_b32 v11, 0, v43, s[76:77]
s_nop 1
v_mfma_f32_16x16x32_bf16 v[24:27], a[0:3], v[8:11], 0
s_mov_b32 s76, 15728880
s_mov_b32 s77, 15728880
v_cndmask_b32 v12, 0, v40, s[76:77]
v_cndmask_b32 v13, 0, v41, s[76:77]
v_cndmask_b32 v14, 0, v42, s[76:77]
v_cndmask_b32 v15, 0, v43, s[76:77]
s_nop 1
v_mfma_f32_16x16x32_bf16 v[24:27], a[4:7], v[12:15], v[24:27]
s_mov_b32 s76, 251662080
s_mov_b32 s77, 251662080
v_cndmask_b32 v16, 0, v40, s[76:77]
v_cndmask_b32 v17, 0, v41, s[76:77]
v_cndmask_b32 v18, 0, v42, s[76:77]
v_cndmask_b32 v19, 0, v43, s[76:77]
s_nop 1
v_mfma_f32_16x16x32_bf16 v[24:27], a[8:11], v[16:19], v[24:27]
s_mov_b32 s76, 4026593280
s_mov_b32 s77, 4026593280
v_cndmask_b32 v20, 0, v40, s[76:77]
v_cndmask_b32 v21, 0, v41, s[76:77]
v_cndmask_b32 v22, 0, v42, s[76:77]
v_cndmask_b32 v23, 0, v43, s[76:77]
s_nop 1
v_mfma_f32_16x16x32_bf16 v[24:27], a[12:15], v[20:23], v[24:27]
v_mfma_f32_16x16x32_bf16 v[28:31], a[16:19], v[8:11], 0
v_mfma_f32_16x16x32_bf16 v[28:31], a[20:23], v[12:15], v[28:31]
v_mfma_f32_16x16x32_bf16 v[28:31], a[24:27], v[16:19], v[28:31]
v_mfma_f32_16x16x32_bf16 v[28:31], a[28:31], v[20:23], v[28:31]
v_mfma_f32_16x16x32_bf16 v[32:35], a[32:35], v[8:11], 0
s_nop 2
v_mov_b32_dpp v40, v24 quad_perm:[0,0,0,0] row_mask:0xf bank_mask:0xf
s_mov_b32 s76, 286331153
s_mov_b32 s77, 286331153
v_mfma_f32_16x16x32_bf16 v[32:35], a[36:39], v[12:15], v[32:35]
v_add_f32_dpp v40, v25, v40 quad_perm:[1,1,1,1] row_mask:0xf bank_mask:0xf
v_mfma_f32_16x16x32_bf16 v[32:35], a[40:43], v[16:19], v[32:35]
v_add_f32_dpp v40, v26, v40 quad_perm:[2,2,2,2] row_mask:0xf bank_mask:0xf
v_mfma_f32_16x16x32_bf16 v[32:35], a[44:47], v[20:23], v[32:35]
v_add_f32_dpp v40, v27, v40 quad_perm:[3,3,3,3] row_mask:0xf bank_mask:0xf
v_cndmask_b32 v36, v36, v40, s[76:77]
v_mfma_f32_16x16x32_bf16 v[24:27], a[48:51], v[8:11], 0
v_mov_b32_dpp v40, v28 quad_perm:[0,0,0,0] row_mask:0xf bank_mask:0xf
s_mov_b32 s76, 572662306
s_mov_b32 s77, 572662306
v_mfma_f32_16x16x32_bf16 v[24:27], a[52:55], v[12:15], v[24:27]
v_add_f32_dpp v40, v29, v40 quad_perm:[1,1,1,1] row_mask:0xf bank_mask:0xf
v_mfma_f32_16x16x32_bf16 v[24:27], a[56:59], v[16:19], v[24:27]
v_add_f32_dpp v40, v30, v40 quad_perm:[2,2,2,2] row_mask:0xf bank_mask:0xf
v_mfma_f32_16x16x32_bf16 v[24:27], a[60:63], v[20:23], v[24:27]
v_add_f32_dpp v40, v31, v40 quad_perm:[3,3,3,3] row_mask:0xf bank_mask:0xf
v_cndmask_b32 v36, v36, v40, s[76:77]
v_mfma_f32_16x16x32_bf16 v[28:31], a[64:67], v[8:11], 0
v_mov_b32_dpp v40, v32 quad_perm:[0,0,0,0] row_mask:0xf bank_mask:0xf
s_mov_b32 s76, 1145324612
s_mov_b32 s77, 1145324612
v_mfma_f32_16x16x32_bf16 v[28:31], a[68:71], v[12:15], v[28:31]
v_add_f32_dpp v40, v33, v40 quad_perm:[1,1,1,1] row_mask:0xf bank_mask:0xf
v_mfma_f32_16x16x32_bf16 v[28:31], a[72:75], v[16:19], v[28:31]
v_add_f32_dpp v40, v34, v40 quad_perm:[2,2,2,2] row_mask:0xf bank_mask:0xf
v_mfma_f32_16x16x32_bf16 v[28:31], a[76:79], v[20:23], v[28:31]
v_add_f32_dpp v40, v35, v40 quad_perm:[3,3,3,3] row_mask:0xf bank_mask:0xf
v_cndmask_b32 v36, v36, v40, s[76:77]
v_mfma_f32_16x16x32_bf16 v[32:35], a[80:83], v[8:11], 0
v_mov_b32_dpp v40, v24 quad_perm:[0,0,0,0] row_mask:0xf bank_mask:0xf
s_mov_b32 s76, 2290649224
s_mov_b32 s77, 2290649224
v_mfma_f32_16x16x32_bf16 v[32:35], a[84:87], v[12:15], v[32:35]
v_add_f32_dpp v40, v25, v40 quad_perm:[1,1,1,1] row_mask:0xf bank_mask:0xf
v_mfma_f32_16x16x32_bf16 v[32:35], a[88:91], v[16:19], v[32:35]
v_add_f32_dpp v40, v26, v40 quad_perm:[2,2,2,2] row_mask:0xf bank_mask:0xf
v_mfma_f32_16x16x32_bf16 v[32:35], a[92:95], v[20:23], v[32:35]
v_add_f32_dpp v40, v27, v40 quad_perm:[3,3,3,3] row_mask:0xf bank_mask:0xf
v_cndmask_b32 v36, v36, v40, s[76:77]
v_mfma_f32_16x16x32_bf16 v[24:27], a[96:99], v[8:11], 0
v_mov_b32_dpp v40, v28 quad_perm:[0,0,0,0] row_mask:0xf bank_mask:0xf
s_mov_b32 s76, 286331153
s_mov_b32 s77, 286331153
v_mfma_f32_16x16x32_bf16 v[24:27], a[100:103], v[12:15], v[24:27]
v_add_f32_dpp v40, v29, v40 quad_perm:[1,1,1,1] row_mask:0xf bank_mask:0xf
v_mfma_f32_16x16x32_bf16 v[24:27], a[104:107], v[16:19], v[24:27]
v_add_f32_dpp v40, v30, v40 quad_perm:[2,2,2,2] row_mask:0xf bank_mask:0xf
v_mfma_f32_16x16x32_bf16 v[24:27], a[108:111], v[20:23], v[24:27]
v_add_f32_dpp v40, v31, v40 quad_perm:[3,3,3,3] row_mask:0xf bank_mask:0xf
v_cndmask_b32 v37, v37, v40, s[76:77]
v_mfma_f32_16x16x32_bf16 v[28:31], a[112:115], v[8:11], 0
v_mov_b32_dpp v40, v32 quad_perm:[0,0,0,0] row_mask:0xf bank_mask:0xf
s_mov_b32 s76, 572662306
s_mov_b32 s77, 572662306
v_mfma_f32_16x16x32_bf16 v[28:31], a[116:119], v[12:15], v[28:31]
v_add_f32_dpp v40, v33, v40 quad_perm:[1,1,1,1] row_mask:0xf bank_mask:0xf
v_mfma_f32_16x16x32_bf16 v[28:31], a[120:123], v[16:19], v[28:31]
v_add_f32_dpp v40, v34, v40 quad_perm:[2,2,2,2] row_mask:0xf bank_mask:0xf
v_mfma_f32_16x16x32_bf16 v[28:31], a[124:127], v[20:23], v[28:31]
v_add_f32_dpp v40, v35, v40 quad_perm:[3,3,3,3] row_mask:0xf bank_mask:0xf
v_cndmask_b32 v37, v37, v40, s[76:77]
ds_read_b128 a[32:35], v44 offset:0
ds_read_b128 a[36:39], v44 offset:1024
v_mfma_f32_16x16x32_bf16 v[32:35], a[128:131], v[8:11], 0
v_mov_b32_dpp v40, v24 quad_perm:[0,0,0,0] row_mask:0xf bank_mask:0xf
s_mov_b32 s76, 1145324612
s_mov_b32 s77, 1145324612
v_mfma_f32_16x16x32_bf16 v[32:35], a[132:135], v[12:15], v[32:35]
v_add_f32_dpp v40, v25, v40 quad_perm:[1,1,1,1] row_mask:0xf bank_mask:0xf
v_mfma_f32_16x16x32_bf16 v[32:35], a[136:139], v[16:19], v[32:35]
v_add_f32_dpp v40, v26, v40 quad_perm:[2,2,2,2] row_mask:0xf bank_mask:0xf
v_mfma_f32_16x16x32_bf16 v[32:35], a[140:143], v[20:23], v[32:35]
v_add_f32_dpp v40, v27, v40 quad_perm:[3,3,3,3] row_mask:0xf bank_mask:0xf
v_cndmask_b32 v37, v37, v40, s[76:77]
ds_read_b128 a[40:43], v44 offset:2048
ds_read_b128 a[44:47], v44 offset:3072
v_mfma_f32_16x16x32_bf16 v[24:27], a[144:147], v[8:11], 0
v_mov_b32_dpp v40, v28 quad_perm:[0,0,0,0] row_mask:0xf bank_mask:0xf
s_mov_b32 s76, 2290649224
s_mov_b32 s77, 2290649224
v_mfma_f32_16x16x32_bf16 v[24:27], a[148:151], v[12:15], v[24:27]
v_add_f32_dpp v40, v29, v40 quad_perm:[1,1,1,1] row_mask:0xf bank_mask:0xf
v_mfma_f32_16x16x32_bf16 v[24:27], a[152:155], v[16:19], v[24:27]
v_add_f32_dpp v40, v30, v40 quad_perm:[2,2,2,2] row_mask:0xf bank_mask:0xf
v_mfma_f32_16x16x32_bf16 v[24:27], a[156:159], v[20:23], v[24:27]
v_add_f32_dpp v40, v31, v40 quad_perm:[3,3,3,3] row_mask:0xf bank_mask:0xf
v_cndmask_b32 v37, v37, v40, s[76:77]
ds_read_b128 a[48:51], v44 offset:4096
ds_read_b128 a[52:55], v44 offset:5120
v_mfma_f32_16x16x32_bf16 v[28:31], a[160:163], v[8:11], 0
v_mov_b32_dpp v40, v32 quad_perm:[0,0,0,0] row_mask:0xf bank_mask:0xf
s_mov_b32 s76, 286331153
s_mov_b32 s77, 286331153
v_mfma_f32_16x16x32_bf16 v[28:31], a[164:167], v[12:15], v[28:31]
v_add_f32_dpp v40, v33, v40 quad_perm:[1,1,1,1] row_mask:0xf bank_mask:0xf
v_mfma_f32_16x16x32_bf16 v[28:31], a[168:171], v[16:19], v[28:31]
v_add_f32_dpp v40, v34, v40 quad_perm:[2,2,2,2] row_mask:0xf bank_mask:0xf
v_mfma_f32_16x16x32_bf16 v[28:31], a[172:175], v[20:23], v[28:31]
v_add_f32_dpp v40, v35, v40 quad_perm:[3,3,3,3] row_mask:0xf bank_mask:0xf
v_cndmask_b32 v38, v38, v40, s[76:77]
ds_read_b128 a[56:59], v44 offset:6144
ds_read_b128 a[60:63], v44 offset:7168
v_mfma_f32_16x16x32_bf16 v[32:35], a[176:179], v[8:11], 0
v_mov_b32_dpp v40, v24 quad_perm:[0,0,0,0] row_mask:0xf bank_mask:0xf
s_mov_b32 s76, 572662306
s_mov_b32 s77, 572662306
v_mfma_f32_16x16x32_bf16 v[32:35], a[180:183], v[12:15], v[32:35]
v_add_f32_dpp v40, v25, v40 quad_perm:[1,1,1,1] row_mask:0xf bank_mask:0xf
v_mfma_f32_16x16x32_bf16 v[32:35], a[184:187], v[16:19], v[32:35]
v_add_f32_dpp v40, v26, v40 quad_perm:[2,2,2,2] row_mask:0xf bank_mask:0xf
v_mfma_f32_16x16x32_bf16 v[32:35], a[188:191], v[20:23], v[32:35]
v_add_f32_dpp v40, v27, v40 quad_perm:[3,3,3,3] row_mask:0xf bank_mask:0xf
v_cndmask_b32 v38, v38, v40, s[76:77]
ds_read_b128 a[64:67], v44 offset:8192
ds_read_b128 a[68:71], v44 offset:9216
v_mfma_f32_16x16x32_bf16 v[24:27], a[192:195], v[8:11], 0
v_mov_b32_dpp v40, v28 quad_perm:[0,0,0,0] row_mask:0xf bank_mask:0xf
s_mov_b32 s76, 1145324612
s_mov_b32 s77, 1145324612
v_mfma_f32_16x16x32_bf16 v[24:27], a[196:199], v[12:15], v[24:27]
v_add_f32_dpp v40, v29, v40 quad_perm:[1,1,1,1] row_mask:0xf bank_mask:0xf
v_mfma_f32_16x16x32_bf16 v[24:27], a[200:203], v[16:19], v[24:27]
v_add_f32_dpp v40, v30, v40 quad_perm:[2,2,2,2] row_mask:0xf bank_mask:0xf
v_mfma_f32_16x16x32_bf16 v[24:27], a[204:207], v[20:23], v[24:27]
v_add_f32_dpp v40, v31, v40 quad_perm:[3,3,3,3] row_mask:0xf bank_mask:0xf
v_cndmask_b32 v38, v38, v40, s[76:77]
ds_read_b128 a[72:75], v44 offset:10240
ds_read_b128 a[76:79], v44 offset:11264
v_mfma_f32_16x16x32_bf16 v[28:31], a[208:211], v[8:11], 0
v_mov_b32_dpp v40, v32 quad_perm:[0,0,0,0] row_mask:0xf bank_mask:0xf
s_mov_b32 s76, 2290649224
s_mov_b32 s77, 2290649224
v_mfma_f32_16x16x32_bf16 v[28:31], a[212:215], v[12:15], v[28:31]
v_add_f32_dpp v40, v33, v40 quad_perm:[1,1,1,1] row_mask:0xf bank_mask:0xf
v_mfma_f32_16x16x32_bf16 v[28:31], a[216:219], v[16:19], v[28:31]
v_add_f32_dpp v40, v34, v40 quad_perm:[2,2,2,2] row_mask:0xf bank_mask:0xf
v_mfma_f32_16x16x32_bf16 v[28:31], a[220:223], v[20:23], v[28:31]
v_add_f32_dpp v40, v35, v40 quad_perm:[3,3,3,3] row_mask:0xf bank_mask:0xf
v_cndmask_b32 v38, v38, v40, s[76:77]
ds_read_b128 a[80:83], v44 offset:12288
ds_read_b128 a[84:87], v44 offset:13312
v_mfma_f32_16x16x32_bf16 v[32:35], a[224:227], v[8:11], 0
v_mov_b32_dpp v40, v24 quad_perm:[0,0,0,0] row_mask:0xf bank_mask:0xf
s_mov_b32 s76, 286331153
s_mov_b32 s77, 286331153
v_mfma_f32_16x16x32_bf16 v[32:35], a[228:231], v[12:15], v[32:35]
v_add_f32_dpp v40, v25, v40 quad_perm:[1,1,1,1] row_mask:0xf bank_mask:0xf
v_mfma_f32_16x16x32_bf16 v[32:35], a[232:235], v[16:19], v[32:35]
v_add_f32_dpp v40, v26, v40 quad_perm:[2,2,2,2] row_mask:0xf bank_mask:0xf
v_mfma_f32_16x16x32_bf16 v[32:35], a[236:239], v[20:23], v[32:35]
v_add_f32_dpp v40, v27, v40 quad_perm:[3,3,3,3] row_mask:0xf bank_mask:0xf
v_cndmask_b32 v39, v39, v40, s[76:77]
ds_read_b128 a[88:91], v44 offset:14336
ds_read_b128 a[92:95], v44 offset:15360
v_mfma_f32_16x16x32_bf16 v[24:27], a[240:243], v[8:11], 0
v_mov_b32_dpp v40, v28 quad_perm:[0,0,0,0] row_mask:0xf bank_mask:0xf
s_mov_b32 s76, 572662306
s_mov_b32 s77, 572662306
v_mfma_f32_16x16x32_bf16 v[24:27], a[244:247], v[12:15], v[24:27]
v_add_f32_dpp v40, v29, v40 quad_perm:[1,1,1,1] row_mask:0xf bank_mask:0xf
v_mfma_f32_16x16x32_bf16 v[24:27], a[248:251], v[16:19], v[24:27]
v_add_f32_dpp v40, v30, v40 quad_perm:[2,2,2,2] row_mask:0xf bank_mask:0xf
v_mfma_f32_16x16x32_bf16 v[24:27], a[252:255], v[20:23], v[24:27]
v_add_f32_dpp v40, v31, v40 quad_perm:[3,3,3,3] row_mask:0xf bank_mask:0xf
v_cndmask_b32 v39, v39, v40, s[76:77]
v_mov_b32_dpp v40, v32 quad_perm:[0,0,0,0] row_mask:0xf bank_mask:0xf
s_mov_b32 s76, 1145324612
s_mov_b32 s77, 1145324612
v_add_f32_dpp v40, v33, v40 quad_perm:[1,1,1,1] row_mask:0xf bank_mask:0xf
v_add_f32_dpp v40, v34, v40 quad_perm:[2,2,2,2] row_mask:0xf bank_mask:0xf
v_add_f32_dpp v40, v35, v40 quad_perm:[3,3,3,3] row_mask:0xf bank_mask:0xf
v_cndmask_b32 v39, v39, v40, s[76:77]
v_mov_b32_dpp v40, v24 quad_perm:[0,0,0,0] row_mask:0xf bank_mask:0xf
s_mov_b32 s76, 2290649224
s_mov_b32 s77, 2290649224
v_add_f32_dpp v40, v25, v40 quad_perm:[1,1,1,1] row_mask:0xf bank_mask:0xf
v_add_f32_dpp v40, v26, v40 quad_perm:[2,2,2,2] row_mask:0xf bank_mask:0xf
v_add_f32_dpp v40, v27, v40 quad_perm:[3,3,3,3] row_mask:0xf bank_mask:0xf
v_cndmask_b32 v39, v39, v40, s[76:77]
v_max3_f32 v40, v36, v37, v38
v_max_f32 v40, v40, v39
s_nop 1
v_max_f32_dpp v40, v40, v40 quad_perm:[1,0,3,2] row_mask:0xf bank_mask:0xf
s_nop 1
v_max_f32_dpp v40, v40, v40 quad_perm:[2,3,0,1] row_mask:0xf bank_mask:0xf
s_nop 1
v_max_f32_dpp v40, v40, v40 row_half_mirror row_mask:0xf bank_mask:0xf
s_nop 1
v_max_f32_dpp v40, v40, v40 row_mirror row_mask:0xf bank_mask:0xf
v_mov_b32 v41, v40
s_nop 1
v_permlane16_swap_b32 v40, v41
v_max_f32 v40, v40, v41
v_mov_b32 v41, v40
s_nop 1
v_permlane32_swap_b32 v40, v41
v_max_f32 v40, v40, v41
v_mul_f32 v40, s82, v40
v_fma_f32 v36, v36, s82, -v40
v_fma_f32 v37, v37, s82, -v40
v_fma_f32 v38, v38, s82, -v40
v_fma_f32 v39, v39, s82, -v40
v_exp_f32 v36, v36
v_exp_f32 v37, v37
v_exp_f32 v38, v38
v_exp_f32 v39, v39
v_cvt_pk_bf16_f32 v42, v36, v37
v_cvt_pk_bf16_f32 v43, v38, v39
ds_write_b64 v45, v[42:43]
ds_read_b128 a[8:11], v46 offset:128
ds_read_b128 a[12:15], v46 offset:192
ds_read_b128 a[16:19], v46 offset:256
ds_read_b128 a[20:23], v46 offset:320
ds_read_b128 a[24:27], v46 offset:384
ds_read_b128 a[28:31], v46 offset:448
ds_read_b128 a[0:3], v46 offset:0
ds_read_b128 a[4:7], v46 offset:64
v_add_f32 v41, v36, v37
v_add_f32 v42, v38, v39
v_add_f32 v41, v41, v42
s_nop 1
v_add_f32_dpp v41, v41, v41 quad_perm:[1,0,3,2] row_mask:0xf bank_mask:0xf
s_nop 1
v_add_f32_dpp v41, v41, v41 quad_perm:[2,3,0,1] row_mask:0xf bank_mask:0xf
s_nop 1
v_add_f32_dpp v41, v41, v41 row_half_mirror row_mask:0xf bank_mask:0xf
s_nop 1
v_add_f32_dpp v41, v41, v41 row_mirror row_mask:0xf bank_mask:0xf
v_mov_b32 v42, v41
s_nop 1
v_permlane16_swap_b32 v41, v42
v_add_f32 v41, v41, v42
v_mov_b32 v42, v41
s_nop 1
v_permlane32_swap_b32 v41, v42
v_add_f32 v41, v41, v42
s_lshl_b32 s3, s62, 3
v_mov_b32 v42, s3
ds_write_b64 v42, v[40:41] offset:29184
s_waitcnt lgkmcnt(8)
v_mfma_f32_16x16x32_bf16 v[8:11], a[8:11], v[128:131], 0
v_mfma_f32_16x16x32_bf16 v[12:15], a[8:11], v[132:135], 0
v_mfma_f32_16x16x32_bf16 v[16:19], a[8:11], v[136:139], 0
v_mfma_f32_16x16x32_bf16 v[20:23], a[8:11], v[140:143], 0
v_mfma_f32_16x16x32_bf16 v[24:27], a[8:11], v[144:147], 0
v_mfma_f32_16x16x32_bf16 v[28:31], a[8:11], v[148:151], 0
v_mfma_f32_16x16x32_bf16 v[32:35], a[8:11], v[152:155], 0
v_mfma_f32_16x16x32_bf16 v[36:39], a[8:11], v[156:159], 0
s_waitcnt lgkmcnt(7)
v_mfma_f32_16x16x32_bf16 v[8:11], a[12:15], v[160:163], v[8:11]
v_mfma_f32_16x16x32_bf16 v[12:15], a[12:15], v[164:167], v[12:15]
v_mfma_f32_16x16x32_bf16 v[16:19], a[12:15], v[168:171], v[16:19]
v_mfma_f32_16x16x32_bf16 v[20:23], a[12:15], v[172:175], v[20:23]
v_mfma_f32_16x16x32_bf16 v[24:27], a[12:15], v[176:179], v[24:27]
v_mfma_f32_16x16x32_bf16 v[28:31], a[12:15], v[180:183], v[28:31]
v_mfma_f32_16x16x32_bf16 v[32:35], a[12:15], v[184:187], v[32:35]
v_mfma_f32_16x16x32_bf16 v[36:39], a[12:15], v[188:191], v[36:39]
s_waitcnt lgkmcnt(6)
v_mfma_f32_16x16x32_bf16 v[8:11], a[16:19], v[192:195], v[8:11]
v_mfma_f32_16x16x32_bf16 v[12:15], a[16:19], v[196:199], v[12:15]
v_mfma_f32_16x16x32_bf16 v[16:19], a[16:19], v[200:203], v[16:19]
v_mfma_f32_16x16x32_bf16 v[20:23], a[16:19], v[204:207], v[20:23]
v_mfma_f32_16x16x32_bf16 v[24:27], a[16:19], v[208:211], v[24:27]
v_mfma_f32_16x16x32_bf16 v[28:31], a[16:19], v[212:215], v[28:31]
v_mfma_f32_16x16x32_bf16 v[32:35], a[16:19], v[216:219], v[32:35]
v_mfma_f32_16x16x32_bf16 v[36:39], a[16:19], v[220:223], v[36:39]
s_waitcnt lgkmcnt(5)
v_mfma_f32_16x16x32_bf16 v[8:11], a[20:23], v[224:227], v[8:11]
v_mfma_f32_16x16x32_bf16 v[12:15], a[20:23], v[228:231], v[12:15]
v_mfma_f32_16x16x32_bf16 v[16:19], a[20:23], v[232:235], v[16:19]
v_mfma_f32_16x16x32_bf16 v[20:23], a[20:23], v[236:239], v[20:23]
v_mfma_f32_16x16x32_bf16 v[24:27], a[20:23], v[240:243], v[24:27]
v_mfma_f32_16x16x32_bf16 v[28:31], a[20:23], v[244:247], v[28:31]
v_mfma_f32_16x16x32_bf16 v[32:35], a[20:23], v[248:251], v[32:35]
v_mfma_f32_16x16x32_bf16 v[36:39], a[20:23], v[252:255], v[36:39]
s_waitcnt lgkmcnt(4)
v_mfma_f32_16x16x32_bf16 v[8:11], a[24:27], v[64:67], v[8:11]
v_mfma_f32_16x16x32_bf16 v[12:15], a[24:27], v[68:71], v[12:15]
v_mfma_f32_16x16x32_bf16 v[16:19], a[24:27], v[72:75], v[16:19]
v_mfma_f32_16x16x32_bf16 v[20:23], a[24:27], v[76:79], v[20:23]
v_mfma_f32_16x16x32_bf16 v[24:27], a[24:27], v[80:83], v[24:27]
v_mfma_f32_16x16x32_bf16 v[28:31], a[24:27], v[84:87], v[28:31]
v_mfma_f32_16x16x32_bf16 v[32:35], a[24:27], v[88:91], v[32:35]
v_mfma_f32_16x16x32_bf16 v[36:39], a[24:27], v[92:95], v[36:39]
s_waitcnt lgkmcnt(3)
v_mfma_f32_16x16x32_bf16 v[8:11], a[28:31], v[96:99], v[8:11]
v_mfma_f32_16x16x32_bf16 v[12:15], a[28:31], v[100:103], v[12:15]
v_mfma_f32_16x16x32_bf16 v[16:19], a[28:31], v[104:107], v[16:19]
v_mfma_f32_16x16x32_bf16 v[20:23], a[28:31], v[108:111], v[20:23]
v_mfma_f32_16x16x32_bf16 v[24:27], a[28:31], v[112:115], v[24:27]
v_mfma_f32_16x16x32_bf16 v[28:31], a[28:31], v[116:119], v[28:31]
v_mfma_f32_16x16x32_bf16 v[32:35], a[28:31], v[120:123], v[32:35]
v_mfma_f32_16x16x32_bf16 v[36:39], a[28:31], v[124:127], v[36:39]
s_waitcnt lgkmcnt(2)
v_mfma_f32_16x16x32_bf16 v[8:11], a[0:3], a[32:35], v[8:11]
v_mfma_f32_16x16x32_bf16 v[12:15], a[0:3], a[36:39], v[12:15]
v_mfma_f32_16x16x32_bf16 v[16:19], a[0:3], a[40:43], v[16:19]
v_mfma_f32_16x16x32_bf16 v[20:23], a[0:3], a[44:47], v[20:23]
v_mfma_f32_16x16x32_bf16 v[24:27], a[0:3], a[48:51], v[24:27]
v_mfma_f32_16x16x32_bf16 v[28:31], a[0:3], a[52:55], v[28:31]
v_mfma_f32_16x16x32_bf16 v[32:35], a[0:3], a[56:59], v[32:35]
v_mfma_f32_16x16x32_bf16 v[36:39], a[0:3], a[60:63], v[36:39]
s_waitcnt lgkmcnt(1)
v_mfma_f32_16x16x32_bf16 v[8:11], a[4:7], a[64:67], v[8:11]
v_mfma_f32_16x16x32_bf16 v[12:15], a[4:7], a[68:71], v[12:15]
v_mfma_f32_16x16x32_bf16 v[16:19], a[4:7], a[72:75], v[16:19]
v_mfma_f32_16x16x32_bf16 v[20:23], a[4:7], a[76:79], v[20:23]
v_mfma_f32_16x16x32_bf16 v[24:27], a[4:7], a[80:83], v[24:27]
v_mfma_f32_16x16x32_bf16 v[28:31], a[4:7], a[84:87], v[28:31]
v_mfma_f32_16x16x32_bf16 v[32:35], a[4:7], a[88:91], v[32:35]
v_mfma_f32_16x16x32_bf16 v[36:39], a[4:7], a[92:95], v[36:39]
v_bfe_u32 v45, v0, 4, 4
v_lshlrev_b32 v45, 5, v45
v_bfe_u32 v47, v0, 10, 2
v_lshl_add_u32 v45, v47, 9, v45
v_add_u32 v45, 4096, v45
v_mov_b32 v9, v12
v_mov_b32 v10, v16
v_mov_b32 v11, v20
v_mov_b32 v25, v28
v_mov_b32 v26, v32
v_mov_b32 v27, v36
s_mov_b64 exec, 0xffff
ds_write_b128 v45, v[8:11]
ds_write_b128 v45, v[24:27] offset:16
s_mov_b64 exec, -1
s_waitcnt lgkmcnt(0)
s_barrier
s_cmp_lg_u32 s62, 0
s_cbranch_scc1 S_74
v_mov_b32 v44, 29184
ds_read_b128 v[24:27], v44
ds_read_b128 v[28:31], v44 offset:16
ds_read_b128 v[8:11], v0 offset:4096
ds_read_b128 v[12:15], v0 offset:4608
ds_read_b128 v[16:19], v0 offset:5120
ds_read_b128 v[20:23], v0 offset:5632
s_mul_i32 s81, s60, 4224
s_lshl_b32 s3, s61, 4
s_add_u32 s81, s81, s3
s_add_u32 s81, s81, 135168
v_lshlrev_b32 v44, 3, v0
s_mov_b32 s76, 0
s_mov_b32 s77, -1
s_waitcnt lgkmcnt(4)
v_max3_f32 v32, v24, v26, v28
v_max_f32 v32, v32, v30
v_sub_f32 v24, v24, v32
v_sub_f32 v26, v26, v32
v_sub_f32 v28, v28, v32
v_sub_f32 v30, v30, v32
v_exp_f32 v24, v24
v_exp_f32 v26, v26
v_exp_f32 v28, v28
v_exp_f32 v30, v30
v_mul_f32 v33, v24, v25
v_fmac_f32 v33, v26, v27
v_fmac_f32 v33, v28, v29
v_fmac_f32 v33, v30, v31
s_waitcnt lgkmcnt(0)
v_mul_f32 v8, v24, v8
v_mul_f32 v9, v24, v9
v_mul_f32 v10, v24, v10
v_mul_f32 v11, v24, v11
v_fmac_f32 v8, v26, v12
v_fmac_f32 v9, v26, v13
v_fmac_f32 v10, v26, v14
v_fmac_f32 v11, v26, v15
v_fmac_f32 v8, v28, v16
v_fmac_f32 v9, v28, v17
v_fmac_f32 v10, v28, v18
v_fmac_f32 v11, v28, v19
v_fmac_f32 v8, v30, v20
v_fmac_f32 v9, v30, v21
v_fmac_f32 v10, v30, v22
v_fmac_f32 v11, v30, v23
v_cndmask_b32 v8, v8, v32, s[76:77]
v_cndmask_b32 v9, v9, v33, s[76:77]
s_mov_b32 exec_hi, 1
buffer_store_dwordx4 v[8:11], v44, s[8:11], s81 offen
buffer_store_dwordx4 v[8:11], v44, s[16:19], s81 offen sc1
s_mov_b64 exec, -1
S_74:
v_bfe_u32 v41, v0, 4, 3
v_lshlrev_b32 v41, 4, v41
v_add_u32 v41, 4096, v41
s_mov_b32 s81, 135168
s_bfe_u32 s3, s60, 327680
s_mul_i32 s3, s3, 4224
s_add_u32 s81, s81, s3
v_bfe_u32 v44, v0, 4, 2
v_lshlrev_b32 v44, 8, v44
v_bfe_u32 v47, v0, 6, 2
v_lshl_add_u32 v44, v47, 12, v44
v_bfe_u32 v47, v0, 8, 1
v_lshl_add_u32 v44, v47, 7, v44
s_mov_b32 s4, 532480
s_bfe_u32 s3, s61, 196608
s_mul_i32 s3, s3, 16384
s_add_u32 s4, s4, s3
s_bfe_u32 s3, s60, 131072
s_mul_i32 s3, s3, 1024
s_add_u32 s4, s4, s3
s_bfe_u32 s3, s60, 196610
s_mul_i32 s3, s3, 16
s_add_u32 s4, s4, s3
v_bfe_u32 v46, v0, 4, 4
v_lshlrev_b32 v46, 4, v46
v_bfe_u32 v47, v0, 8, 4
v_lshl_add_u32 v46, v47, 15, v46
s_barrier
s_sleep 4
s_mov_b32 s80, 0
buffer_load_dwordx2 v[12:13], v41, s[8:11], s81 offen
buffer_load_dwordx4 v[8:11], v0, s[8:11], s81 offen
s_waitcnt vmcnt(0)
P_75:
v_max3_u32 v18, v8, v9, v13
v_max3_u32 v18, v18, v10, v11
v_max3_u32 v18, v18, v12, v13
v_cmp_eq_u32 vcc, -1, v18
s_nop 0
s_cbranch_vccnz R_77
D_76:
v_max_f32_dpp v18, v12, v12 quad_perm:[1,0,3,2] row_mask:0xf bank_mask:0xf
s_nop 1
v_max_f32_dpp v18, v18, v18 quad_perm:[2,3,0,1] row_mask:0xf bank_mask:0xf
v_sub_f32 v12, v12, v18
v_exp_f32 v12, v12
s_nop 0
v_mul_f32 v13, v12, v13
v_mul_f32 v8, v12, v8
v_mul_f32 v9, v12, v9
v_mul_f32 v10, v12, v10
v_mul_f32 v11, v12, v11
v_add_f32_dpp v13, v13, v13 quad_perm:[1,0,3,2] row_mask:0xf bank_mask:0xf
v_add_f32_dpp v8, v8, v8 quad_perm:[1,0,3,2] row_mask:0xf bank_mask:0xf
v_add_f32_dpp v9, v9, v9 quad_perm:[1,0,3,2] row_mask:0xf bank_mask:0xf
v_add_f32_dpp v10, v10, v10 quad_perm:[1,0,3,2] row_mask:0xf bank_mask:0xf
v_add_f32_dpp v11, v11, v11 quad_perm:[1,0,3,2] row_mask:0xf bank_mask:0xf
v_add_f32_dpp v13, v13, v13 quad_perm:[2,3,0,1] row_mask:0xf bank_mask:0xf
v_rcp_f32 v13, v13
v_add_f32_dpp v8, v8, v8 quad_perm:[2,3,0,1] row_mask:0xf bank_mask:0xf
v_add_f32_dpp v9, v9, v9 quad_perm:[2,3,0,1] row_mask:0xf bank_mask:0xf
v_add_f32_dpp v10, v10, v10 quad_perm:[2,3,0,1] row_mask:0xf bank_mask:0xf
v_add_f32_dpp v11, v11, v11 quad_perm:[2,3,0,1] row_mask:0xf bank_mask:0xf
v_mul_f32 v8, v13, v8
v_mul_f32 v9, v13, v9
v_mul_f32 v10, v13, v10
v_mul_f32 v11, v13, v11
v_cvt_pk_bf16_f32 v8, v8, v9
v_cvt_pk_bf16_f32 v9, v10, v11
v_perm_b32 v12, v8, v8, v1
v_perm_b32 v13, v8, v8, v2
v_cndmask_b32 v16, 0, v12, s[72:73]
v_cndmask_b32 v17, 0, v12, s[74:75]
v_cndmask_b32 v18, 0, v13, s[72:73]
v_cndmask_b32 v19, 0, v13, s[74:75]
v_perm_b32 v14, v9, v9, v1
v_perm_b32 v15, v9, v9, v2
v_cndmask_b32 v20, 0, v14, s[72:73]
v_cndmask_b32 v21, 0, v14, s[74:75]
v_cndmask_b32 v22, 0, v15, s[72:73]
v_cndmask_b32 v23, 0, v15, s[74:75]
v_mfma_f32_16x16x32_bf16 v[36:39], v[16:19], v[48:51], 0
v_cndmask_b32 v24, 0, v12, s[96:97]
v_cndmask_b32 v25, 0, v12, s[98:99]
v_cndmask_b32 v26, 0, v13, s[96:97]
v_cndmask_b32 v27, 0, v13, s[98:99]
v_mfma_f32_16x16x32_bf16 v[36:39], v[20:23], v[52:55], v[36:39]
v_cndmask_b32 v28, 0, v14, s[96:97]
v_cndmask_b32 v29, 0, v14, s[98:99]
v_cndmask_b32 v30, 0, v15, s[96:97]
v_cndmask_b32 v31, 0, v15, s[98:99]
v_mfma_f32_16x16x32_bf16 v[36:39], v[24:27], v[56:59], v[36:39]
s_nop 0
v_mfma_f32_16x16x32_bf16 v[36:39], v[28:31], v[60:63], v[36:39]
s_nop 7
ds_write_b128 v0, v[36:39] offset:0
buffer_load_dwordx4 v[48:51], v46, s[28:31], s86 offen
buffer_load_dwordx4 v[52:55], v46, s[28:31], s87 offen
buffer_load_dwordx4 v[56:59], v46, s[28:31], s88 offen
buffer_load_dwordx4 v[60:63], v46, s[28:31], s89 offen
s_waitcnt lgkmcnt(0)
s_barrier
s_cmp_lg_u32 s62, 0
s_cbranch_scc1 S_81
ds_read_b128 v[8:11], v0 offset:0
ds_read_b128 v[12:15], v0 offset:512
ds_read_b128 v[16:19], v0 offset:1024
ds_read_b128 v[20:23], v0 offset:1536
ds_read_b128 v[24:27], v0 offset:2048
ds_read_b128 v[28:31], v0 offset:2560
ds_read_b128 v[32:35], v0 offset:3072
ds_read_b128 v[36:39], v0 offset:3584
s_waitcnt lgkmcnt(6)
v_pk_add_f32 v[8:9], v[8:9], v[12:13]
v_pk_add_f32 v[10:11], v[10:11], v[14:15]
s_waitcnt lgkmcnt(4)
v_pk_add_f32 v[16:17], v[16:17], v[20:21]
v_pk_add_f32 v[18:19], v[18:19], v[22:23]
s_waitcnt lgkmcnt(2)
v_pk_add_f32 v[24:25], v[24:25], v[28:29]
v_pk_add_f32 v[26:27], v[26:27], v[30:31]
s_waitcnt lgkmcnt(0)
v_pk_add_f32 v[32:33], v[32:33], v[36:37]
v_pk_add_f32 v[34:35], v[34:35], v[38:39]
v_pk_add_f32 v[8:9], v[8:9], v[16:17]
v_pk_add_f32 v[10:11], v[10:11], v[18:19]
v_pk_add_f32 v[24:25], v[24:25], v[32:33]
v_pk_add_f32 v[26:27], v[26:27], v[34:35]
v_pk_add_f32 v[8:9], v[8:9], v[24:25]
v_pk_add_f32 v[10:11], v[10:11], v[26:27]
s_mov_b32 exec_lo, -1
s_mov_b32 exec_hi, 0
buffer_store_dwordx4 v[8:11], v44, s[16:19], s4 offen sc1
s_mov_b64 exec, -1
S_81:
s_nop 0
v_bfe_u32 v44, v0, 4, 4
v_lshlrev_b32 v44, 8, v44
v_bfe_u32 v47, v0, 8, 1
v_lshl_add_u32 v44, v47, 7, v44
v_bfe_u32 v47, v0, 9, 1
v_lshl_add_u32 v44, v47, 6, v44
s_mov_b32 s4, 1327104
s_bfe_u32 s3, s60, 327680
s_mul_i32 s3, s3, 8320
s_add_u32 s4, s4, s3
s_bfe_u32 s3, s61, 65538
s_mul_i32 s3, s3, 4096
s_add_u32 s4, s4, s3
s_bfe_u32 s3, s61, 131072
s_mul_i32 s3, s3, 16
s_add_u32 s4, s4, s3
s_mov_b32 s100, 1335296
s_bfe_u32 s3, s60, 327680
s_mul_i32 s3, s3, 8320
s_add_u32 s100, s100, s3
s_bfe_u32 s3, s61, 196608
s_mul_i32 s3, s3, 16
s_add_u32 s100, s100, s3
v_bfe_u32 v46, v0, 4, 4
v_lshlrev_b32 v46, 13, v46
v_bfe_u32 v47, v0, 8, 2
v_lshl_add_u32 v46, v47, 4, v46
v_bfe_u32 v47, v0, 10, 2
v_lshl_add_u32 v46, v47, 17, v46
v_bfe_u32 v45, v0, 9, 1
v_lshlrev_b32 v45, 3, v45
v_mov_b32 v28, 0x3f803f80
v_mov_b32 v29, v28
v_mov_b32 v30, v28
v_mov_b32 v31, v28
s_mov_b32 s81, 532480
s_bfe_u32 s3, s61, 196608
s_mul_i32 s3, s3, 16384
s_add_u32 s81, s81, s3
s_bfe_u32 s3, s62, 131072
s_mul_i32 s3, s3, 3072
s_add_u32 s81, s81, s3
s_barrier
v_bfe_u32 v193, v0, 7, 1
v_bfe_u32 v194, v0, 4, 3
v_lshl_or_b32 v193, v194, 1, v193
v_bfe_u32 v194, v0, 8, 2
v_lshlrev_b32 v194, 2, v194
v_xor_b32 v193, v193, v194
v_bfe_u32 v192, v0, 4, 4
v_lshlrev_b32 v192, 8, v192
v_bfe_u32 v47, v0, 10, 2
v_lshl_add_u32 v192, v47, 14, v192
v_add_u32 v192, 98304, v192
v_lshl_add_u32 v192, v193, 4, v192
v_xor_b32 v193, 16, v192
v_xor_b32 v194, 32, v192
v_xor_b32 v195, 48, v192
ds_read_b128 v[64:67], v192 offset:0
ds_read_b128 v[68:71], v193 offset:0
ds_read_b128 v[72:75], v194 offset:0
ds_read_b128 v[76:79], v195 offset:0
ds_read_b128 v[80:83], v192 offset:4096
ds_read_b128 v[84:87], v193 offset:4096
ds_read_b128 v[88:91], v194 offset:4096
ds_read_b128 v[92:95], v195 offset:4096
ds_read_b128 v[96:99], v192 offset:8192
ds_read_b128 v[100:103], v193 offset:8192
ds_read_b128 v[104:107], v194 offset:8192
ds_read_b128 v[108:111], v195 offset:8192
ds_read_b128 v[112:115], v192 offset:12288
ds_read_b128 v[116:119], v193 offset:12288
ds_read_b128 v[120:123], v194 offset:12288
ds_read_b128 v[124:127], v195 offset:12288
s_waitcnt lgkmcnt(0)
s_sleep 13
s_mov_b32 s80, 0
buffer_load_dwordx4 v[8:11], v0, s[16:19], s81 offen offset:0 sc1
buffer_load_dwordx4 v[12:15], v0, s[16:19], s81 offen offset:1024 sc1
buffer_load_dwordx4 v[16:19], v0, s[16:19], s81 offen offset:2048 sc1
buffer_load_dwordx4 v[20:23], v0, s[16:19], s81 offen offset:3072 sc1
s_waitcnt vmcnt(0)
P_82:
v_max3_u32 v24, v8, v9, v23
v_max3_u32 v24, v24, v10, v11
v_max3_u32 v24, v24, v12, v13
v_max3_u32 v24, v24, v14, v15
v_max3_u32 v24, v24, v16, v17
v_max3_u32 v24, v24, v18, v19
v_max3_u32 v24, v24, v20, v21
v_max3_u32 v24, v24, v22, v23
v_cmp_eq_u32 vcc, -1, v24
s_nop 0
s_cbranch_vccnz R_84
D_83:
v_pk_add_f32 v[8:9], v[8:9], v[12:13]
v_pk_add_f32 v[16:17], v[16:17], v[20:21]
v_pk_add_f32 v[10:11], v[10:11], v[14:15]
v_pk_add_f32 v[18:19], v[18:19], v[22:23]
v_pk_add_f32 v[8:9], v[8:9], v[16:17]
v_pk_add_f32 v[10:11], v[10:11], v[18:19]
s_nop 0
v_add_f32_dpp v8, v8, v8 quad_perm:[1,0,3,2] row_mask:0xf bank_mask:0xf
v_add_f32_dpp v9, v9, v9 quad_perm:[1,0,3,2] row_mask:0xf bank_mask:0xf
v_add_f32_dpp v10, v10, v10 quad_perm:[1,0,3,2] row_mask:0xf bank_mask:0xf
v_add_f32_dpp v11, v11, v11 quad_perm:[1,0,3,2] row_mask:0xf bank_mask:0xf
v_add_f32_dpp v8, v8, v8 quad_perm:[2,3,0,1] row_mask:0xf bank_mask:0xf
v_add_f32_dpp v9, v9, v9 quad_perm:[2,3,0,1] row_mask:0xf bank_mask:0xf
v_add_f32_dpp v10, v10, v10 quad_perm:[2,3,0,1] row_mask:0xf bank_mask:0xf
v_add_f32_dpp v11, v11, v11 quad_perm:[2,3,0,1] row_mask:0xf bank_mask:0xf
v_add_f32_dpp v8, v8, v8 row_half_mirror row_mask:0xf bank_mask:0xf
v_add_f32_dpp v9, v9, v9 row_half_mirror row_mask:0xf bank_mask:0xf
v_add_f32_dpp v10, v10, v10 row_half_mirror row_mask:0xf bank_mask:0xf
v_add_f32_dpp v11, v11, v11 row_half_mirror row_mask:0xf bank_mask:0xf
v_cvt_pk_bf16_f32 v8, v8, v9
v_cvt_pk_bf16_f32 v9, v10, v11
v_lshlrev_b32 v10, 16, v8
v_and_b32 v11, s83, v8
v_lshlrev_b32 v12, 16, v9
v_and_b32 v13, s83, v9
v_pk_add_f32 v[4:5], v[4:5], v[10:11]
v_pk_add_f32 v[6:7], v[6:7], v[12:13]
v_cvt_pk_bf16_f32 v8, v4, v5
v_cvt_pk_bf16_f32 v9, v6, v7
v_perm_b32 v10, v8, v8, v1
v_cndmask_b32 v12, 0, v10, s[64:65]
v_cndmask_b32 v13, 0, v10, s[66:67]
v_cndmask_b32 v14, 0, v10, s[68:69]
v_cndmask_b32 v15, 0, v10, s[70:71]
v_perm_b32 v10, v8, v8, v2
v_cndmask_b32 v16, 0, v10, s[64:65]
v_cndmask_b32 v17, 0, v10, s[66:67]
v_cndmask_b32 v18, 0, v10, s[68:69]
v_cndmask_b32 v19, 0, v10, s[70:71]
v_mfma_f32_16x16x32_bf16 v[36:39], v[12:15], v[48:51], 0
v_mfma_f32_16x16x32_bf16 v[40:43], v[12:15], v[28:31], 0
v_mfma_f32_16x16x32_bf16 v[32:35], v[12:15], v[12:15], 0
v_perm_b32 v10, v9, v9, v1
v_cndmask_b32 v20, 0, v10, s[64:65]
v_cndmask_b32 v21, 0, v10, s[66:67]
v_cndmask_b32 v22, 0, v10, s[68:69]
v_cndmask_b32 v23, 0, v10, s[70:71]
v_mfma_f32_16x16x32_bf16 v[36:39], v[16:19], v[52:55], v[36:39]
v_mfma_f32_16x16x32_bf16 v[40:43], v[16:19], v[28:31], v[40:43]
v_mfma_f32_16x16x32_bf16 v[32:35], v[16:19], v[16:19], v[32:35]
v_perm_b32 v10, v9, v9, v2
v_cndmask_b32 v24, 0, v10, s[64:65]
v_cndmask_b32 v25, 0, v10, s[66:67]
v_cndmask_b32 v26, 0, v10, s[68:69]
v_cndmask_b32 v27, 0, v10, s[70:71]
v_mfma_f32_16x16x32_bf16 v[36:39], v[20:23], v[56:59], v[36:39]
v_mfma_f32_16x16x32_bf16 v[40:43], v[20:23], v[28:31], v[40:43]
v_mfma_f32_16x16x32_bf16 v[32:35], v[20:23], v[20:23], v[32:35]
v_mfma_f32_16x16x32_bf16 v[36:39], v[24:27], v[60:63], v[36:39]
v_mfma_f32_16x16x32_bf16 v[40:43], v[24:27], v[28:31], v[40:43]
v_mfma_f32_16x16x32_bf16 v[32:35], v[24:27], v[24:27], v[32:35]
v_lshlrev_b32 v4, 16, v8
v_and_b32 v5, s83, v8
v_lshlrev_b32 v6, 16, v9
v_and_b32 v7, s83, v9
s_nop 1
ds_write_b128 v0, v[36:39] offset:4096
s_nop 0
v_mov_b32 v41, v32
ds_write_b64 v0, v[40:41] offset:24576
buffer_load_dwordx4 v[48:51], v46, s[32:35], 0 offen offset:0
buffer_load_dwordx4 v[52:55], v46, s[32:35], 0 offen offset:64
buffer_load_dwordx4 v[56:59], v46, s[32:35], 0 offen offset:128
buffer_load_dwordx4 v[60:63], v46, s[32:35], 0 offen offset:192
s_waitcnt lgkmcnt(0)
s_barrier
s_cmp_lg_u32 s62, 0
s_cbranch_scc1 S_89
ds_read_b128 v[8:11], v0 offset:4096
ds_read_b128 v[12:15], v0 offset:5120
ds_read_b128 v[16:19], v0 offset:6144
ds_read_b128 v[20:23], v0 offset:7168
s_waitcnt lgkmcnt(2)
v_pk_add_f32 v[8:9], v[8:9], v[12:13]
v_pk_add_f32 v[10:11], v[10:11], v[14:15]
s_waitcnt lgkmcnt(0)
v_pk_add_f32 v[16:17], v[16:17], v[20:21]
v_pk_add_f32 v[18:19], v[18:19], v[22:23]
v_pk_add_f32 v[8:9], v[8:9], v[16:17]
v_pk_add_f32 v[10:11], v[10:11], v[18:19]
buffer_store_dwordx4 v[8:11], v44, s[8:11], s4 offen
buffer_store_dwordx4 v[8:11], v44, s[16:19], s4 offen sc1
s_mov_b64 exec, -1
S_89:
s_cmp_lg_u32 s62, 2
s_cbranch_scc1 S_90
ds_read_b64 v[8:9], v0 offset:22528
ds_read_b64 v[12:13], v0 offset:23552
ds_read_b64 v[16:17], v0 offset:24576
ds_read_b64 v[20:21], v0 offset:25600
s_waitcnt lgkmcnt(2)
v_pk_add_f32 v[8:9], v[8:9], v[12:13]
s_waitcnt lgkmcnt(0)
v_pk_add_f32 v[16:17], v[16:17], v[20:21]
v_pk_add_f32 v[8:9], v[8:9], v[16:17]
s_mov_b32 exec_lo, 1
s_mov_b32 exec_hi, 256
buffer_store_dwordx2 v[8:9], v45, s[8:11], s100 offen
buffer_store_dwordx2 v[8:9], v45, s[16:19], s100 offen sc1
s_mov_b64 exec, -1
S_90:
v_bfe_u32 v41, v0, 4, 2
v_lshlrev_b32 v41, 4, v41
v_bfe_u32 v47, v0, 6, 1
v_lshl_add_u32 v41, v47, 3, v41
v_add_u32 v41, 8192, v41
s_mov_b32 s81, 1327104
s_bfe_u32 s3, s60, 327680
s_mul_i32 s3, s3, 8320
s_add_u32 s81, s81, s3
s_add_u32 s100, s81, 4096
v_bfe_u32 v42, v0, 6, 1
v_lshlrev_b32 v42, 8, v42
v_bfe_u32 v47, v0, 7, 5
v_lshl_add_u32 v42, v47, 3, v42
v_add_u32 v42, 28672, v42
v_bfe_u32 v39, v0, 7, 5
v_lshlrev_b32 v39, 4, v39
v_add_u32 v39, 30208, v39
v_bfe_u32 v43, v0, 4, 1
v_lshlrev_b32 v43, 8, v43
v_bfe_u32 v47, v0, 8, 2
v_lshl_add_u32 v43, v47, 4, v43
v_add_u32 v43, 28672, v43
v_bfe_u32 v44, v0, 4, 1
v_lshlrev_b32 v44, 15, v44
v_bfe_u32 v47, v0, 8, 1
v_lshl_add_u32 v44, v47, 3, v44
v_bfe_u32 v47, v0, 9, 1
v_lshl_add_u32 v44, v47, 10, v44
v_bfe_u32 v47, v0, 10, 1
v_lshl_add_u32 v44, v47, 11, v44
v_bfe_u32 v47, v0, 11, 1
v_lshl_add_u32 v44, v47, 8, v44
s_mov_b32 s4, 1855488
s_bfe_u32 s3, s60, 65540
s_mul_i32 s3, s3, 16384
s_add_u32 s4, s4, s3
s_bfe_u32 s3, s61, 131073
s_mul_i32 s3, s3, 4096
s_add_u32 s4, s4, s3
s_bfe_u32 s3, s61, 65536
s_mul_i32 s3, s3, 512
s_add_u32 s4, s4, s3
s_bfe_u32 s3, s60, 262144
s_mul_i32 s3, s3, 16
s_add_u32 s4, s4, s3
ds_read_b128 v[20:23], v39
s_barrier
s_sleep 5
s_mov_b32 s80, 0
buffer_load_dwordx2 v[16:17], v41, s[8:11], s81 offen
buffer_load_dwordx2 v[18:19], v41, s[8:11], s81 offen offset:64
buffer_load_dwordx4 v[8:11], v0, s[8:11], s81 offen
buffer_load_dwordx4 v[12:15], v0, s[8:11], s100 offen
s_waitcnt vmcnt(0)
P_91:
v_max3_u32 v30, v8, v9, v19
v_max3_u32 v30, v30, v10, v11
v_max3_u32 v30, v30, v12, v13
v_max3_u32 v30, v30, v14, v15
v_max3_u32 v30, v30, v16, v17
v_max3_u32 v30, v30, v18, v19
v_cmp_eq_u32 vcc, -1, v30
s_nop 0
s_cbranch_vccnz R_93
D_92:
v_pk_add_f32 v[16:17], v[16:17], v[18:19]
v_pk_add_f32 v[8:9], v[8:9], v[12:13]
v_pk_add_f32 v[10:11], v[10:11], v[14:15]
v_add_f32_dpp v16, v16, v16 quad_perm:[1,0,3,2] row_mask:0xf bank_mask:0xf
v_add_f32_dpp v17, v17, v17 quad_perm:[1,0,3,2] row_mask:0xf bank_mask:0xf
v_add_f32_dpp v8, v8, v8 quad_perm:[1,0,3,2] row_mask:0xf bank_mask:0xf
v_add_f32_dpp v9, v9, v9 quad_perm:[1,0,3,2] row_mask:0xf bank_mask:0xf
v_add_f32_dpp v10, v10, v10 quad_perm:[1,0,3,2] row_mask:0xf bank_mask:0xf
v_add_f32_dpp v11, v11, v11 quad_perm:[1,0,3,2] row_mask:0xf bank_mask:0xf
v_add_f32_dpp v16, v16, v16 quad_perm:[2,3,0,1] row_mask:0xf bank_mask:0xf
v_add_f32_dpp v17, v17, v17 quad_perm:[2,3,0,1] row_mask:0xf bank_mask:0xf
v_add_f32_dpp v8, v8, v8 quad_perm:[2,3,0,1] row_mask:0xf bank_mask:0xf
v_add_f32_dpp v9, v9, v9 quad_perm:[2,3,0,1] row_mask:0xf bank_mask:0xf
v_add_f32_dpp v10, v10, v10 quad_perm:[2,3,0,1] row_mask:0xf bank_mask:0xf
v_add_f32_dpp v11, v11, v11 quad_perm:[2,3,0,1] row_mask:0xf bank_mask:0xf
v_mul_f32 v16, s91, v16
v_mul_f32 v17, s91, v17
v_fma_f32 v17, -v16, v16, v17
v_max_f32 v17, 0, v17
v_add_f32 v17, s92, v17
v_rsq_f32 v17, v17
s_waitcnt lgkmcnt(0)
v_fma_f32 v8, -v16, v20, v8
v_fma_f32 v9, -v16, v21, v9
v_fma_f32 v10, -v16, v22, v10
v_fma_f32 v11, -v16, v23, v11
v_mul_f32 v8, v17, v8
v_mul_f32 v9, v17, v9
v_mul_f32 v10, v17, v10
v_mul_f32 v11, v17, v11
v_cvt_pk_bf16_f32 v8, v8, v9
v_cvt_pk_bf16_f32 v9, v10, v11
ds_write_b64 v42, v[8:9]
s_waitcnt lgkmcnt(0)
s_barrier
ds_read_b128 v[8:11], v43 offset:0
ds_read_b128 v[12:15], v43 offset:64
ds_read_b128 v[16:19], v43 offset:128
ds_read_b128 v[20:23], v43 offset:192
s_waitcnt lgkmcnt(3)
v_mfma_f32_16x16x32_bf16 v[24:27], v[48:51], v[8:11], 0
s_waitcnt lgkmcnt(2)
v_mfma_f32_16x16x32_bf16 v[24:27], v[52:55], v[12:15], v[24:27]
s_waitcnt lgkmcnt(1)
v_mfma_f32_16x16x32_bf16 v[24:27], v[56:59], v[16:19], v[24:27]
s_waitcnt lgkmcnt(0)
v_mfma_f32_16x16x32_bf16 v[24:27], v[60:63], v[20:23], v[24:27]
s_mov_b32 exec_lo, 0x00030003
s_mov_b32 exec_hi, 0x00030003
s_nop 5
v_cvt_pk_bf16_f32 v24, v24, v25
v_cvt_pk_bf16_f32 v25, v26, v27
buffer_store_dwordx2 v[24:25], v44, s[16:19], s4 offen sc1
s_mov_b64 exec, -1
s_mov_b32 s81, 1855488
s_bfe_u32 s3, s6, 65542
s_mul_i32 s3, s3, 32768
s_add_u32 s81, s81, s3
s_bfe_u32 s3, s7, 65536
s_mul_i32 s3, s3, 16384
s_add_u32 s81, s81, s3
s_bfe_u32 s3, s62, 131072
s_mul_i32 s3, s3, 3072
s_add_u32 s81, s81, s3
s_mov_b32 s4, 8388608
s_bfe_u32 s3, s6, 458752
s_mul_i32 s3, s3, 32768
s_add_u32 s4, s4, s3
s_bfe_u32 s3, s7, 65536
s_mul_i32 s3, s3, 16384
s_add_u32 s4, s4, s3
s_mov_b32 s100, 1953792
s_bfe_u32 s3, s6, 458752
s_mul_i32 s3, s3, 8
s_add_u32 s100, s100, s3
s_bfe_u32 s3, s7, 65536
s_mul_i32 s3, s3, 16384
s_add_u32 s100, s100, s3
v_bfe_u32 v61, v0, 6, 3
v_bfe_u32 v62, v0, 9, 1
v_lshl_or_b32 v61, v61, 1, v62
v_bfe_u32 v62, v0, 5, 1
v_xor_b32 v61, v61, v62
v_bfe_u32 v60, v0, 4, 1
v_lshlrev_b32 v60, 3, v60
v_bfe_u32 v47, v0, 6, 4
v_lshl_add_u32 v60, v47, 8, v60
v_bfe_u32 v47, v0, 10, 2
v_lshl_add_u32 v60, v47, 14, v60
v_add_u32 v60, 98304, v60
v_lshl_add_u32 v60, v61, 4, v60
v_bfe_u32 v62, v0, 4, 4
v_lshlrev_b32 v62, 4, v62
v_bfe_u32 v47, v0, 8, 2
v_lshl_add_u32 v62, v47, 12, v62
v_bfe_u32 v47, v0, 10, 2
v_lshl_add_u32 v62, v47, 8, v62
v_bfe_u32 v63, v0, 4, 4
v_lshlrev_b32 v63, 10, v63
v_xor_b32 v41, 1024, v0
v_xor_b32 v42, 2048, v0
v_xor_b32 v43, 3072, v0
v_xor_b32 v61, 0, v60
ds_read_b64_tr_b16 v[128:129], v61 offset:0
ds_read_b64_tr_b16 v[130:131], v61 offset:4096
ds_read_b64_tr_b16 v[132:133], v61 offset:8192
ds_read_b64_tr_b16 v[134:135], v61 offset:12288
v_xor_b32 v61, 32, v60
ds_read_b64_tr_b16 v[136:137], v61 offset:0
ds_read_b64_tr_b16 v[138:139], v61 offset:4096
ds_read_b64_tr_b16 v[140:141], v61 offset:8192
ds_read_b64_tr_b16 v[142:143], v61 offset:12288
v_xor_b32 v61, 64, v60
ds_read_b64_tr_b16 v[144:145], v61 offset:0
ds_read_b64_tr_b16 v[146:147], v61 offset:4096
ds_read_b64_tr_b16 v[148:149], v61 offset:8192
ds_read_b64_tr_b16 v[150:151], v61 offset:12288
v_xor_b32 v61, 96, v60
ds_read_b64_tr_b16 v[152:153], v61 offset:0
ds_read_b64_tr_b16 v[154:155], v61 offset:4096
ds_read_b64_tr_b16 v[156:157], v61 offset:8192
ds_read_b64_tr_b16 v[158:159], v61 offset:12288
v_xor_b32 v61, 128, v60
ds_read_b64_tr_b16 v[160:161], v61 offset:0
ds_read_b64_tr_b16 v[162:163], v61 offset:4096
ds_read_b64_tr_b16 v[164:165], v61 offset:8192
ds_read_b64_tr_b16 v[166:167], v61 offset:12288
v_xor_b32 v61, 160, v60
ds_read_b64_tr_b16 v[168:169], v61 offset:0
ds_read_b64_tr_b16 v[170:171], v61 offset:4096
ds_read_b64_tr_b16 v[172:173], v61 offset:8192
ds_read_b64_tr_b16 v[174:175], v61 offset:12288
v_xor_b32 v61, 192, v60
ds_read_b64_tr_b16 v[176:177], v61 offset:0
ds_read_b64_tr_b16 v[178:179], v61 offset:4096
ds_read_b64_tr_b16 v[180:181], v61 offset:8192
ds_read_b64_tr_b16 v[182:183], v61 offset:12288
v_xor_b32 v61, 224, v60
ds_read_b64_tr_b16 v[184:185], v61 offset:0
ds_read_b64_tr_b16 v[186:187], v61 offset:4096
ds_read_b64_tr_b16 v[188:189], v61 offset:8192
ds_read_b64_tr_b16 v[190:191], v61 offset:12288
s_waitcnt lgkmcnt(0)
s_sleep 11
s_mov_b32 s80, 0
buffer_load_dwordx4 v[8:11], v0, s[16:19], s81 offen offset:0 sc1
buffer_load_dwordx4 v[12:15], v0, s[16:19], s81 offen offset:1024 sc1
buffer_load_dwordx4 v[16:19], v0, s[16:19], s81 offen offset:2048 sc1
buffer_load_dwordx4 v[20:23], v0, s[16:19], s81 offen offset:3072 sc1
s_waitcnt vmcnt(0)
P_99:
v_max3_u32 v24, v8, v9, v23
v_max3_u32 v24, v24, v10, v11
v_max3_u32 v24, v24, v12, v13
v_max3_u32 v24, v24, v14, v15
v_max3_u32 v24, v24, v16, v17
v_max3_u32 v24, v24, v18, v19
v_max3_u32 v24, v24, v20, v21
v_max3_u32 v24, v24, v22, v23
v_cmp_eq_u32 vcc, -1, v24
s_nop 0
s_cbranch_vccnz R_101
D_100:
v_mfma_f32_16x16x32_bf16 v[24:27], v[64:67], v[8:11], 0
v_mfma_f32_16x16x32_bf16 v[28:31], v[80:83], v[8:11], 0
v_mfma_f32_16x16x32_bf16 v[32:35], v[96:99], v[8:11], 0
v_mfma_f32_16x16x32_bf16 v[36:39], v[112:115], v[8:11], 0
v_mfma_f32_16x16x32_bf16 v[24:27], v[68:71], v[12:15], v[24:27]
v_mfma_f32_16x16x32_bf16 v[28:31], v[84:87], v[12:15], v[28:31]
v_mfma_f32_16x16x32_bf16 v[32:35], v[100:103], v[12:15], v[32:35]
v_mfma_f32_16x16x32_bf16 v[36:39], v[116:119], v[12:15], v[36:39]
v_mfma_f32_16x16x32_bf16 v[24:27], v[72:75], v[16:19], v[24:27]
v_mfma_f32_16x16x32_bf16 v[28:31], v[88:91], v[16:19], v[28:31]
v_mfma_f32_16x16x32_bf16 v[32:35], v[104:107], v[16:19], v[32:35]
v_mfma_f32_16x16x32_bf16 v[36:39], v[120:123], v[16:19], v[36:39]
v_mfma_f32_16x16x32_bf16 v[24:27], v[76:79], v[20:23], v[24:27]
v_mfma_f32_16x16x32_bf16 v[28:31], v[92:95], v[20:23], v[28:31]
v_mfma_f32_16x16x32_bf16 v[32:35], v[108:111], v[20:23], v[32:35]
v_mfma_f32_16x16x32_bf16 v[36:39], v[124:127], v[20:23], v[36:39]
s_nop 4
ds_write_b128 v0, v[24:27] offset:8192
ds_write_b128 v0, v[28:31] offset:12288
ds_write_b128 v0, v[32:35] offset:16384
ds_write_b128 v0, v[36:39] offset:20480
s_waitcnt lgkmcnt(0)
s_barrier
ds_read_b128 v[8:11], v41 offset:8192
ds_read_b128 v[12:15], v41 offset:12288
ds_read_b128 v[16:19], v41 offset:16384
ds_read_b128 v[20:23], v41 offset:20480
ds_read_b128 v[44:47], v42 offset:8192
ds_read_b128 v[48:51], v42 offset:12288
ds_read_b128 v[52:55], v42 offset:16384
ds_read_b128 v[56:59], v42 offset:20480
s_waitcnt lgkmcnt(7)
v_pk_add_f32 v[24:25], v[24:25], v[8:9]
v_pk_add_f32 v[26:27], v[26:27], v[10:11]
ds_read_b128 v[8:11], v43 offset:8192
s_waitcnt lgkmcnt(7)
v_pk_add_f32 v[28:29], v[28:29], v[12:13]
v_pk_add_f32 v[30:31], v[30:31], v[14:15]
ds_read_b128 v[12:15], v43 offset:12288
s_waitcnt lgkmcnt(7)
v_pk_add_f32 v[32:33], v[32:33], v[16:17]
v_pk_add_f32 v[34:35], v[34:35], v[18:19]
ds_read_b128 v[16:19], v43 offset:16384
s_waitcnt lgkmcnt(7)
v_pk_add_f32 v[36:37], v[36:37], v[20:21]
v_pk_add_f32 v[38:39], v[38:39], v[22:23]
ds_read_b128 v[20:23], v43 offset:20480
s_waitcnt lgkmcnt(3)
v_pk_add_f32 v[44:45], v[44:45], v[8:9]
v_pk_add_f32 v[46:47], v[46:47], v[10:11]
v_pk_add_f32 v[24:25], v[24:25], v[44:45]
v_pk_add_f32 v[26:27], v[26:27], v[46:47]
s_waitcnt lgkmcnt(2)
v_pk_add_f32 v[48:49], v[48:49], v[12:13]
v_pk_add_f32 v[50:51], v[50:51], v[14:15]
v_pk_add_f32 v[28:29], v[28:29], v[48:49]
v_pk_add_f32 v[30:31], v[30:31], v[50:51]
s_waitcnt lgkmcnt(1)
v_pk_add_f32 v[52:53], v[52:53], v[16:17]
v_pk_add_f32 v[54:55], v[54:55], v[18:19]
v_pk_add_f32 v[32:33], v[32:33], v[52:53]
v_pk_add_f32 v[34:35], v[34:35], v[54:55]
s_waitcnt lgkmcnt(0)
v_pk_add_f32 v[56:57], v[56:57], v[20:21]
v_pk_add_f32 v[58:59], v[58:59], v[22:23]
v_pk_add_f32 v[36:37], v[36:37], v[56:57]
v_pk_add_f32 v[38:39], v[38:39], v[58:59]
v_max3_f32 v40, v24, v25, v26
v_max3_f32 v41, v27, v28, v29
v_max3_f32 v40, v40, v30, v31
v_max3_f32 v41, v41, v32, v33
v_max3_f32 v40, v40, v34, v35
v_max3_f32 v41, v41, v36, v37
v_max3_f32 v40, v40, v38, v39
v_max_f32 v40, v40, v41
v_mov_b32 v41, v40
s_nop 1
v_permlane16_swap_b32 v40, v41
v_max_f32 v40, v40, v41
v_mov_b32 v41, v40
s_nop 1
v_permlane32_swap_b32 v40, v41
v_max_f32 v40, v40, v41
v_mul_f32 v40, s82, v40
v_fma_f32 v24, v24, s82, -v40
v_fma_f32 v25, v25, s82, -v40
v_fma_f32 v26, v26, s82, -v40
v_fma_f32 v27, v27, s82, -v40
v_fma_f32 v28, v28, s82, -v40
v_fma_f32 v29, v29, s82, -v40
v_fma_f32 v30, v30, s82, -v40
v_fma_f32 v31, v31, s82, -v40
v_fma_f32 v32, v32, s82, -v40
v_fma_f32 v33, v33, s82, -v40
v_fma_f32 v34, v34, s82, -v40
v_fma_f32 v35, v35, s82, -v40
v_fma_f32 v36, v36, s82, -v40
v_fma_f32 v37, v37, s82, -v40
v_fma_f32 v38, v38, s82, -v40
v_fma_f32 v39, v39, s82, -v40
v_exp_f32 v24, v24
v_exp_f32 v25, v25
v_exp_f32 v26, v26
v_exp_f32 v27, v27
v_exp_f32 v28, v28
v_exp_f32 v29, v29
v_exp_f32 v30, v30
v_exp_f32 v31, v31
v_exp_f32 v32, v32
v_exp_f32 v33, v33
v_exp_f32 v34, v34
v_exp_f32 v35, v35
v_exp_f32 v36, v36
v_exp_f32 v37, v37
v_exp_f32 v38, v38
v_exp_f32 v39, v39
v_cvt_pk_bf16_f32 v8, v24, v25
v_cvt_pk_bf16_f32 v9, v26, v27
v_cvt_pk_bf16_f32 v10, v28, v29
v_cvt_pk_bf16_f32 v11, v30, v31
v_cvt_pk_bf16_f32 v12, v32, v33
v_cvt_pk_bf16_f32 v13, v34, v35
v_cvt_pk_bf16_f32 v14, v36, v37
v_cvt_pk_bf16_f32 v15, v38, v39
v_mfma_f32_16x16x32_bf16 v[16:19], v[8:11], v[128:131], 0
v_pk_add_f32 v[32:33], v[32:33], v[24:25]
v_pk_add_f32 v[34:35], v[34:35], v[26:27]
v_mfma_f32_16x16x32_bf16 v[16:19], v[12:15], v[132:135], v[16:19]
v_pk_add_f32 v[36:37], v[36:37], v[28:29]
v_pk_add_f32 v[38:39], v[38:39], v[30:31]
v_mfma_f32_16x16x32_bf16 v[20:23], v[8:11], v[136:139], 0
v_pk_add_f32 v[32:33], v[32:33], v[36:37]
v_pk_add_f32 v[34:35], v[34:35], v[38:39]
v_mfma_f32_16x16x32_bf16 v[20:23], v[12:15], v[140:143], v[20:23]
v_pk_add_f32 v[32:33], v[32:33], v[34:35]
v_add_f32 v41, v32, v33
v_mfma_f32_16x16x32_bf16 v[24:27], v[8:11], v[144:147], 0
v_mov_b32 v42, v41
s_nop 1
v_permlane16_swap_b32 v41, v42
v_add_f32 v41, v41, v42
v_mov_b32 v42, v41
s_nop 1
v_permlane32_swap_b32 v41, v42
v_add_f32 v41, v41, v42
v_mfma_f32_16x16x32_bf16 v[24:27], v[12:15], v[148:151], v[24:27]
s_cmp_lg_u32 s62, 0
s_cbranch_scc1 S_106
s_mov_b64 exec, 0xffff
buffer_store_dwordx2 v[40:41], v63, s[16:19], s100 offen sc1
s_mov_b64 exec, -1
S_106:
v_mfma_f32_16x16x32_bf16 v[28:31], v[8:11], v[152:155], 0
v_mfma_f32_16x16x32_bf16 v[28:31], v[12:15], v[156:159], v[28:31]
v_cvt_pk_bf16_f32 v32, v16, v20
v_cvt_pk_bf16_f32 v36, v17, v21
v_cvt_pk_bf16_f32 v40, v18, v22
v_cvt_pk_bf16_f32 v44, v19, v23
v_mfma_f32_16x16x32_bf16 v[16:19], v[8:11], v[160:163], 0
v_mfma_f32_16x16x32_bf16 v[16:19], v[12:15], v[164:167], v[16:19]
v_mfma_f32_16x16x32_bf16 v[20:23], v[8:11], v[168:171], 0
v_mfma_f32_16x16x32_bf16 v[20:23], v[12:15], v[172:175], v[20:23]
v_cvt_pk_bf16_f32 v33, v24, v28
v_cvt_pk_bf16_f32 v37, v25, v29
v_cvt_pk_bf16_f32 v41, v26, v30
v_cvt_pk_bf16_f32 v45, v27, v31
v_mfma_f32_16x16x32_bf16 v[24:27], v[8:11], v[176:179], 0
v_mfma_f32_16x16x32_bf16 v[24:27], v[12:15], v[180:183], v[24:27]
v_mfma_f32_16x16x32_bf16 v[28:31], v[8:11], v[184:187], 0
v_mfma_f32_16x16x32_bf16 v[28:31], v[12:15], v[188:191], v[28:31]
v_cvt_pk_bf16_f32 v34, v16, v20
v_cvt_pk_bf16_f32 v38, v17, v21
v_cvt_pk_bf16_f32 v42, v18, v22
v_cvt_pk_bf16_f32 v46, v19, v23
s_nop 3
v_cvt_pk_bf16_f32 v35, v24, v28
buffer_store_dwordx4 v[32:35], v62, s[16:19], s4 offen offset:0 sc1
v_cvt_pk_bf16_f32 v39, v25, v29
buffer_store_dwordx4 v[36:39], v62, s[16:19], s4 offen offset:1024 sc1
v_cvt_pk_bf16_f32 v43, v26, v30
buffer_store_dwordx4 v[40:43], v62, s[16:19], s4 offen offset:2048 sc1
v_cvt_pk_bf16_f32 v47, v27, v31
buffer_store_dwordx4 v[44:47], v62, s[16:19], s4 offen offset:3072 sc1
v_bfe_u32 v31, v0, 4, 4
v_lshlrev_b32 v31, 4, v31
v_bfe_u32 v47, v0, 8, 1
v_lshl_add_u32 v31, v47, 19, v31
v_bfe_u32 v47, v0, 9, 3
v_lshl_add_u32 v31, v47, 13, v31
s_mov_b32 s5, 0
buffer_load_dwordx4 v[48:51], v31, s[36:39], s5 offen
s_mov_b32 s5, 131072
buffer_load_dwordx4 v[52:55], v31, s[36:39], s5 offen
s_mov_b32 s5, 262144
buffer_load_dwordx4 v[56:59], v31, s[36:39], s5 offen
s_mov_b32 s5, 393216
buffer_load_dwordx4 v[60:63], v31, s[36:39], s5 offen
v_bfe_u32 v40, v0, 4, 3
v_lshlrev_b32 v40, 4, v40
v_bfe_u32 v47, v0, 7, 5
v_lshl_add_u32 v40, v47, 17, v40
v_bfe_u32 v41, v0, 7, 5
v_lshlrev_b32 v41, 5, v41
v_add_u32 v42, 32768, v40
s_mov_b32 s100, 8388608
s_bfe_u32 s3, s93, 524288
s_mul_i32 s3, s3, 128
s_add_u32 s100, s100, s3
s_add_u32 s101, s100, 65536
s_mov_b32 s81, 1953792
s_bfe_u32 s3, s60, 327680
s_mul_i32 s3, s3, 1024
s_add_u32 s81, s81, s3
v_bfe_u32 v45, v0, 4, 3
v_lshlrev_b32 v45, 5, v45
v_bfe_u32 v47, v0, 8, 1
v_lshl_add_u32 v45, v47, 4, v45
v_bfe_u32 v47, v0, 9, 3
v_lshl_add_u32 v45, v47, 8, v45
v_add_u32 v45, 0, v45
v_bfe_u32 v46, v0, 4, 4
v_lshlrev_b32 v46, 3, v46
v_bfe_u32 v47, v0, 8, 4
v_lshl_add_u32 v46, v47, 13, v46
s_sleep 22
s_mov_b32 s80, 0
buffer_load_dwordx4 v[24:27], v41, s[16:19], s81 offen offset:0 sc1
buffer_load_dwordx4 v[28:31], v41, s[16:19], s81 offen offset:16 sc1
buffer_load_dwordx4 v[8:11], v40, s[16:19], s100 offen sc1
buffer_load_dwordx4 v[12:15], v42, s[16:19], s100 offen sc1
buffer_load_dwordx4 v[16:19], v40, s[16:19], s101 offen sc1
buffer_load_dwordx4 v[20:23], v42, s[16:19], s101 offen sc1
s_waitcnt vmcnt(0)
P_107:
v_max3_u32 v44, v8, v9, v31
v_max3_u32 v44, v44, v10, v11
v_max3_u32 v44, v44, v12, v13
v_max3_u32 v44, v44, v14, v15
v_max3_u32 v44, v44, v16, v17
v_max3_u32 v44, v44, v18, v19
v_max3_u32 v44, v44, v20, v21
v_max3_u32 v44, v44, v22, v23
v_max3_u32 v44, v44, v24, v25
v_max3_u32 v44, v44, v26, v27
v_max3_u32 v44, v44, v28, v29
v_max3_u32 v44, v44, v30, v31
v_cmp_eq_u32 vcc, -1, v44
s_nop 0
s_cbranch_vccnz R_109
D_108:
v_max3_f32 v44, v24, v26, v28
v_max_f32 v44, v44, v30
s_nop 1
v_max_f32_dpp v44, v44, v44 row_ror:8 row_mask:0xf bank_mask:0xf
v_mov_b32 v43, v44
s_nop 1
v_permlane16_swap_b32 v44, v43
v_max_f32 v44, v44, v43
v_mov_b32 v43, v44
s_nop 1
v_permlane32_swap_b32 v44, v43
v_max_f32 v44, v44, v43
v_sub_f32 v24, v24, v44
v_sub_f32 v26, v26, v44
v_sub_f32 v28, v28, v44
v_sub_f32 v30, v30, v44
v_exp_f32 v24, v24
v_exp_f32 v26, v26
v_exp_f32 v28, v28
v_exp_f32 v30, v30
v_cvt_pk_bf16_f32 v24, v24, v26
v_cvt_pk_bf16_f32 v26, v28, v30
v_perm_b32 v47, v24, v24, v1
v_cndmask_b32 v32, 0, v47, s[64:65]
v_cndmask_b32 v33, 0, v47, s[66:67]
v_cndmask_b32 v34, 0, v47, s[68:69]
v_cndmask_b32 v35, 0, v47, s[70:71]
v_perm_b32 v47, v24, v24, v2
v_cndmask_b32 v36, 0, v47, s[64:65]
v_cndmask_b32 v37, 0, v47, s[66:67]
v_cndmask_b32 v38, 0, v47, s[68:69]
v_cndmask_b32 v39, 0, v47, s[70:71]
v_mfma_f32_16x16x32_bf16 v[40:43], v[32:35], v[8:11], 0
v_perm_b32 v47, v26, v26, v1
v_cndmask_b32 v32, 0, v47, s[64:65]
v_cndmask_b32 v33, 0, v47, s[66:67]
v_cndmask_b32 v34, 0, v47, s[68:69]
v_cndmask_b32 v35, 0, v47, s[70:71]
v_mfma_f32_16x16x32_bf16 v[40:43], v[36:39], v[12:15], v[40:43]
v_perm_b32 v47, v26, v26, v2
v_cndmask_b32 v36, 0, v47, s[64:65]
v_cndmask_b32 v37, 0, v47, s[66:67]
v_cndmask_b32 v38, 0, v47, s[68:69]
v_cndmask_b32 v39, 0, v47, s[70:71]
v_mfma_f32_16x16x32_bf16 v[40:43], v[32:35], v[16:19], v[40:43]
s_nop 0
v_mfma_f32_16x16x32_bf16 v[40:43], v[36:39], v[20:23], v[40:43]
v_lshlrev_b32 v28, 16, v24
v_and_b32 v30, s83, v24
v_mul_f32 v25, v28, v25
v_fmac_f32 v25, v30, v27
v_lshlrev_b32 v28, 16, v26
v_and_b32 v30, s83, v26
v_fmac_f32 v25, v28, v29
v_fmac_f32 v25, v30, v31
s_mov_b32 exec_lo, 0x00ff00ff
s_mov_b32 exec_hi, 0xff00ff00
ds_write_b128 v45, v[40:43]
s_mov_b64 exec, -1
v_add_f32_dpp v25, v25, v25 row_ror:8 row_mask:0xf bank_mask:0xf
v_mov_b32 v28, v25
s_nop 1
v_permlane16_swap_b32 v25, v28
v_add_f32 v25, v25, v28
v_mov_b32 v28, v25
s_nop 1
v_permlane32_swap_b32 v25, v28
v_add_f32 v25, v25, v28
s_lshl_b32 s3, s62, 3
v_mov_b32 v24, v44
v_mov_b32 v28, s3
ds_write_b64 v28, v[24:25] offset:29216
v_bfe_u32 v32, v0, 7, 1
v_lshlrev_b32 v32, 10, v32
v_bfe_u32 v47, v0, 8, 4
v_lshl_add_u32 v32, v47, 4, v32
v_add_u32 v32, 0, v32
v_bfe_u32 v33, v0, 7, 1
v_lshlrev_b32 v33, 4, v33
s_waitcnt lgkmcnt(0)
s_barrier
ds_read_b128 v[24:27], v33 offset:29216
ds_read_b128 v[8:11], v32 offset:0
ds_read_b128 v[12:15], v32 offset:256
ds_read_b128 v[16:19], v32 offset:512
ds_read_b128 v[20:23], v32 offset:768
v_bfe_u32 v44, v0, 4, 2
v_lshlrev_b32 v44, 8, v44
v_bfe_u32 v47, v0, 6, 2
v_lshl_add_u32 v44, v47, 11, v44
v_bfe_u32 v47, v0, 8, 1
v_lshl_add_u32 v44, v47, 7, v44
v_bfe_u32 v47, v0, 9, 1
v_lshl_add_u32 v44, v47, 6, v44
s_mov_b32 s4, 2248704
s_bfe_u32 s3, s60, 327680
s_mul_i32 s3, s3, 8192
s_add_u32 s4, s4, s3
s_bfe_u32 s3, s61, 65538
s_mul_i32 s3, s3, 1024
s_add_u32 s4, s4, s3
s_bfe_u32 s3, s61, 131072
s_mul_i32 s3, s3, 16
s_add_u32 s4, s4, s3
s_waitcnt lgkmcnt(4)
v_max_f32 v28, v24, v26
v_sub_f32 v24, v24, v28
v_sub_f32 v26, v26, v28
v_exp_f32 v24, v24
v_exp_f32 v26, v26
v_mul_f32 v25, v24, v25
v_fmac_f32 v25, v26, v27
v_rcp_f32 v25, v25
s_waitcnt lgkmcnt(0)
v_pk_add_f32 v[8:9], v[8:9], v[12:13]
v_pk_add_f32 v[16:17], v[16:17], v[20:21]
v_pk_add_f32 v[10:11], v[10:11], v[14:15]
v_pk_add_f32 v[18:19], v[18:19], v[22:23]
v_mul_f32 v24, v24, v25
v_mul_f32 v26, v26, v25
v_mul_f32 v8, v24, v8
v_mul_f32 v9, v24, v9
v_mul_f32 v10, v24, v10
v_mul_f32 v11, v24, v11
v_fmac_f32 v8, v26, v16
v_fmac_f32 v9, v26, v17
v_fmac_f32 v10, v26, v18
v_fmac_f32 v11, v26, v19
v_cvt_pk_bf16_f32 v8, v8, v9
v_cvt_pk_bf16_f32 v9, v10, v11
v_perm_b32 v10, v8, v8, v1
v_cndmask_b32 v12, 0, v10, s[64:65]
v_cndmask_b32 v13, 0, v10, s[66:67]
v_cndmask_b32 v14, 0, v10, s[68:69]
v_cndmask_b32 v15, 0, v10, s[70:71]
v_perm_b32 v10, v8, v8, v2
v_cndmask_b32 v16, 0, v10, s[64:65]
v_cndmask_b32 v17, 0, v10, s[66:67]
v_cndmask_b32 v18, 0, v10, s[68:69]
v_cndmask_b32 v19, 0, v10, s[70:71]
v_mfma_f32_16x16x32_bf16 v[36:39], v[12:15], v[48:51], 0
v_perm_b32 v10, v9, v9, v1
v_cndmask_b32 v20, 0, v10, s[64:65]
v_cndmask_b32 v21, 0, v10, s[66:67]
v_cndmask_b32 v22, 0, v10, s[68:69]
v_cndmask_b32 v23, 0, v10, s[70:71]
v_mfma_f32_16x16x32_bf16 v[36:39], v[16:19], v[52:55], v[36:39]
v_perm_b32 v10, v9, v9, v2
v_cndmask_b32 v24, 0, v10, s[64:65]
v_cndmask_b32 v25, 0, v10, s[66:67]
v_cndmask_b32 v26, 0, v10, s[68:69]
v_cndmask_b32 v27, 0, v10, s[70:71]
v_mfma_f32_16x16x32_bf16 v[36:39], v[20:23], v[56:59], v[36:39]
s_nop 0
v_mfma_f32_16x16x32_bf16 v[36:39], v[24:27], v[60:63], v[36:39]
s_nop 7
ds_write_b128 v0, v[36:39] offset:4096
buffer_load_dwordx2 v[48:49], v46, s[40:43], 0 offen offset:0
buffer_load_dwordx2 v[50:51], v46, s[40:43], 0 offen offset:1024
buffer_load_dwordx2 v[52:53], v46, s[40:43], 0 offen offset:2048
buffer_load_dwordx2 v[54:55], v46, s[40:43], 0 offen offset:3072
buffer_load_dwordx2 v[56:57], v46, s[40:43], s90 offen offset:0
buffer_load_dwordx2 v[58:59], v46, s[40:43], s90 offen offset:1024
buffer_load_dwordx2 v[60:61], v46, s[40:43], s90 offen offset:2048
buffer_load_dwordx2 v[62:63], v46, s[40:43], s90 offen offset:3072
s_waitcnt lgkmcnt(0)
s_barrier
s_cmp_lg_u32 s62, 0
s_cbranch_scc1 S_116
ds_read_b128 v[8:11], v0 offset:4096
ds_read_b128 v[12:15], v0 offset:5120
ds_read_b128 v[16:19], v0 offset:6144
ds_read_b128 v[20:23], v0 offset:7168
s_waitcnt lgkmcnt(2)
v_pk_add_f32 v[8:9], v[8:9], v[12:13]
v_pk_add_f32 v[10:11], v[10:11], v[14:15]
s_waitcnt lgkmcnt(0)
v_pk_add_f32 v[16:17], v[16:17], v[20:21]
v_pk_add_f32 v[18:19], v[18:19], v[22:23]
v_pk_add_f32 v[8:9], v[8:9], v[16:17]
v_pk_add_f32 v[10:11], v[10:11], v[18:19]
buffer_store_dwordx4 v[8:11], v44, s[8:11], s4 offen
buffer_store_dwordx4 v[8:11], v44, s[16:19], s4 offen sc1
s_mov_b64 exec, -1
S_116:
s_mov_b32 s81, 2248704
s_bfe_u32 s3, s60, 327680
s_mul_i32 s3, s3, 8192
s_add_u32 s81, s81, s3
s_bfe_u32 s3, s62, 131072
s_mul_i32 s3, s3, 1024
s_add_u32 s81, s81, s3
v_bfe_u32 v44, v0, 4, 2
v_lshlrev_b32 v44, 8, v44
v_bfe_u32 v47, v0, 6, 2
v_lshl_add_u32 v44, v47, 12, v44
v_bfe_u32 v47, v0, 8, 1
v_lshl_add_u32 v44, v47, 7, v44
s_mov_b32 s4, 663552
s_bfe_u32 s3, s61, 196608
s_mul_i32 s3, s3, 16384
s_add_u32 s4, s4, s3
s_bfe_u32 s3, s60, 131072
s_mul_i32 s3, s3, 1024
s_add_u32 s4, s4, s3
s_bfe_u32 s3, s60, 196610
s_mul_i32 s3, s3, 16
s_add_u32 s4, s4, s3
s_barrier
s_sleep 5
s_mov_b32 s80, 0
buffer_load_dwordx4 v[8:11], v0, s[8:11], s81 offen
buffer_load_dwordx4 v[12:15], v0, s[8:11], s81 offen offset:1024
s_waitcnt vmcnt(0)
P_117:
v_max3_u32 v18, v8, v9, v15
v_max3_u32 v18, v18, v10, v11
v_max3_u32 v18, v18, v12, v13
v_max3_u32 v18, v18, v14, v15
v_cmp_eq_u32 vcc, -1, v18
s_nop 0
s_cbranch_vccnz R_119
D_118:
v_pk_add_f32 v[8:9], v[8:9], v[12:13]
v_pk_add_f32 v[10:11], v[10:11], v[14:15]
s_nop 0
v_add_f32_dpp v8, v8, v8 quad_perm:[1,0,3,2] row_mask:0xf bank_mask:0xf
v_add_f32_dpp v9, v9, v9 quad_perm:[1,0,3,2] row_mask:0xf bank_mask:0xf
v_add_f32_dpp v10, v10, v10 quad_perm:[1,0,3,2] row_mask:0xf bank_mask:0xf
v_add_f32_dpp v11, v11, v11 quad_perm:[1,0,3,2] row_mask:0xf bank_mask:0xf
v_add_f32_dpp v8, v8, v8 quad_perm:[2,3,0,1] row_mask:0xf bank_mask:0xf
v_add_f32_dpp v9, v9, v9 quad_perm:[2,3,0,1] row_mask:0xf bank_mask:0xf
v_add_f32_dpp v10, v10, v10 quad_perm:[2,3,0,1] row_mask:0xf bank_mask:0xf
v_add_f32_dpp v11, v11, v11 quad_perm:[2,3,0,1] row_mask:0xf bank_mask:0xf
v_cvt_pk_bf16_f32 v8, v8, v9
v_cvt_pk_bf16_f32 v9, v10, v11
v_perm_b32 v12, v8, v8, v1
v_perm_b32 v13, v8, v8, v2
v_cndmask_b32 v16, 0, v12, s[72:73]
v_cndmask_b32 v17, 0, v12, s[74:75]
v_cndmask_b32 v18, 0, v13, s[72:73]
v_cndmask_b32 v19, 0, v13, s[74:75]
v_perm_b32 v14, v9, v9, v1
v_perm_b32 v15, v9, v9, v2
v_cndmask_b32 v20, 0, v14, s[72:73]
v_cndmask_b32 v21, 0, v14, s[74:75]
v_cndmask_b32 v22, 0, v15, s[72:73]
v_cndmask_b32 v23, 0, v15, s[74:75]
v_mfma_f32_16x16x32_bf16 v[36:39], v[16:19], v[48:51], 0
v_cndmask_b32 v24, 0, v12, s[96:97]
v_cndmask_b32 v25, 0, v12, s[98:99]
v_cndmask_b32 v26, 0, v13, s[96:97]
v_cndmask_b32 v27, 0, v13, s[98:99]
v_mfma_f32_16x16x32_bf16 v[36:39], v[20:23], v[52:55], v[36:39]
v_cndmask_b32 v28, 0, v14, s[96:97]
v_cndmask_b32 v29, 0, v14, s[98:99]
v_cndmask_b32 v30, 0, v15, s[96:97]
v_cndmask_b32 v31, 0, v15, s[98:99]
v_mfma_f32_16x16x32_bf16 v[36:39], v[24:27], v[56:59], v[36:39]
s_nop 0
v_mfma_f32_16x16x32_bf16 v[36:39], v[28:31], v[60:63], v[36:39]
s_nop 7
ds_write_b128 v0, v[36:39] offset:0
s_waitcnt lgkmcnt(0)
s_barrier
s_cmp_lg_u32 s62, 0
s_cbranch_scc1 S_123
ds_read_b128 v[8:11], v0 offset:0
ds_read_b128 v[12:15], v0 offset:512
ds_read_b128 v[16:19], v0 offset:1024
ds_read_b128 v[20:23], v0 offset:1536
ds_read_b128 v[24:27], v0 offset:2048
ds_read_b128 v[28:31], v0 offset:2560
ds_read_b128 v[32:35], v0 offset:3072
ds_read_b128 v[36:39], v0 offset:3584
s_waitcnt lgkmcnt(6)
v_pk_add_f32 v[8:9], v[8:9], v[12:13]
v_pk_add_f32 v[10:11], v[10:11], v[14:15]
s_waitcnt lgkmcnt(4)
v_pk_add_f32 v[16:17], v[16:17], v[20:21]
v_pk_add_f32 v[18:19], v[18:19], v[22:23]
s_waitcnt lgkmcnt(2)
v_pk_add_f32 v[24:25], v[24:25], v[28:29]
v_pk_add_f32 v[26:27], v[26:27], v[30:31]
s_waitcnt lgkmcnt(0)
v_pk_add_f32 v[32:33], v[32:33], v[36:37]
v_pk_add_f32 v[34:35], v[34:35], v[38:39]
v_pk_add_f32 v[8:9], v[8:9], v[16:17]
v_pk_add_f32 v[10:11], v[10:11], v[18:19]
v_pk_add_f32 v[24:25], v[24:25], v[32:33]
v_pk_add_f32 v[26:27], v[26:27], v[34:35]
v_pk_add_f32 v[8:9], v[8:9], v[24:25]
v_pk_add_f32 v[10:11], v[10:11], v[26:27]
s_mov_b32 exec_lo, -1
s_mov_b32 exec_hi, 0
buffer_store_dwordx4 v[8:11], v44, s[16:19], s4 offen sc1
s_mov_b64 exec, -1
S_123:
s_cmp_lg_u32 s60, 0
s_cbranch_scc1 L_fin
s_mov_b32 s81, 663552
s_bfe_u32 s3, s61, 196608
s_mul_i32 s3, s3, 16384
s_add_u32 s81, s81, s3
s_bfe_u32 s3, s62, 131072
s_mul_i32 s3, s3, 3072
s_add_u32 s81, s81, s3
s_barrier
s_sleep 17
s_mov_b32 s80, 0
buffer_load_dwordx4 v[8:11], v0, s[16:19], s81 offen offset:0 sc1
buffer_load_dwordx4 v[12:15], v0, s[16:19], s81 offen offset:1024 sc1
buffer_load_dwordx4 v[16:19], v0, s[16:19], s81 offen offset:2048 sc1
buffer_load_dwordx4 v[20:23], v0, s[16:19], s81 offen offset:3072 sc1
s_waitcnt vmcnt(0)
P_124:
v_max3_u32 v24, v8, v9, v23
v_max3_u32 v24, v24, v10, v11
v_max3_u32 v24, v24, v12, v13
v_max3_u32 v24, v24, v14, v15
v_max3_u32 v24, v24, v16, v17
v_max3_u32 v24, v24, v18, v19
v_max3_u32 v24, v24, v20, v21
v_max3_u32 v24, v24, v22, v23
v_cmp_eq_u32 vcc, -1, v24
s_nop 0
s_cbranch_vccnz R_126
D_125:
v_pk_add_f32 v[8:9], v[8:9], v[12:13]
v_pk_add_f32 v[16:17], v[16:17], v[20:21]
v_pk_add_f32 v[10:11], v[10:11], v[14:15]
v_pk_add_f32 v[18:19], v[18:19], v[22:23]
v_pk_add_f32 v[8:9], v[8:9], v[16:17]
v_pk_add_f32 v[10:11], v[10:11], v[18:19]
s_nop 0
v_add_f32_dpp v8, v8, v8 quad_perm:[1,0,3,2] row_mask:0xf bank_mask:0xf
v_add_f32_dpp v9, v9, v9 quad_perm:[1,0,3,2] row_mask:0xf bank_mask:0xf
v_add_f32_dpp v10, v10, v10 quad_perm:[1,0,3,2] row_mask:0xf bank_mask:0xf
v_add_f32_dpp v11, v11, v11 quad_perm:[1,0,3,2] row_mask:0xf bank_mask:0xf
v_add_f32_dpp v8, v8, v8 quad_perm:[2,3,0,1] row_mask:0xf bank_mask:0xf
v_add_f32_dpp v9, v9, v9 quad_perm:[2,3,0,1] row_mask:0xf bank_mask:0xf
v_add_f32_dpp v10, v10, v10 quad_perm:[2,3,0,1] row_mask:0xf bank_mask:0xf
v_add_f32_dpp v11, v11, v11 quad_perm:[2,3,0,1] row_mask:0xf bank_mask:0xf
v_add_f32_dpp v8, v8, v8 row_half_mirror row_mask:0xf bank_mask:0xf
v_add_f32_dpp v9, v9, v9 row_half_mirror row_mask:0xf bank_mask:0xf
v_add_f32_dpp v10, v10, v10 row_half_mirror row_mask:0xf bank_mask:0xf
v_add_f32_dpp v11, v11, v11 row_half_mirror row_mask:0xf bank_mask:0xf
v_cvt_pk_bf16_f32 v8, v8, v9
v_cvt_pk_bf16_f32 v9, v10, v11
v_lshlrev_b32 v10, 16, v8
v_and_b32 v11, s83, v8
v_lshlrev_b32 v12, 16, v9
v_and_b32 v13, s83, v9
v_pk_add_f32 v[4:5], v[4:5], v[10:11]
v_pk_add_f32 v[6:7], v[6:7], v[12:13]
v_cvt_pk_bf16_f32 v8, v4, v5
v_cvt_pk_bf16_f32 v9, v6, v7
v_bfe_u32 v44, v0, 7, 1
v_lshlrev_b32 v44, 10, v44
v_bfe_u32 v47, v0, 8, 4
v_lshl_add_u32 v44, v47, 3, v44
s_lshl_b32 s3, s61, 7
s_mov_b32 exec_lo, 0x01010101
s_mov_b32 exec_hi, 0x01010101
buffer_store_dwordx2 v[8:9], v44, s[48:51], s3 offen
s_mov_b64 exec, -1
L_fin:
L_end:
s_endpgm
R_7:
s_add_u32 s80, s80, 1
s_cmp_gt_u32 s80, 200000
s_cbranch_scc1 D_6
s_cmp_gt_u32 s80, 8
s_cbranch_scc1 F_8
buffer_load_dwordx2 v[12:13], v41, s[8:11], s81 offen sc1
buffer_load_dwordx4 v[8:11], v0, s[8:11], s81 offen sc1
s_waitcnt vmcnt(0)
s_branch P_5
F_8:
s_sleep 1
buffer_load_dwordx2 v[12:13], v41, s[16:19], s81 offen sc1
s_mov_b64 exec, -1
K_9:
buffer_load_dwordx4 v[8:11], v0, s[16:19], s81 offen sc1
s_mov_b64 exec, -1
K_10:
s_waitcnt vmcnt(0)
s_branch P_5
R_14:
s_add_u32 s80, s80, 1
s_cmp_gt_u32 s80, 200000
s_cbranch_scc1 D_13
s_sleep 1
buffer_load_dwordx4 v[8:11], v0, s[16:19], s81 offen offset:0 sc1
s_mov_b64 exec, -1
K_15:
buffer_load_dwordx4 v[12:15], v0, s[16:19], s81 offen offset:1024 sc1
s_mov_b64 exec, -1
K_16:
buffer_load_dwordx4 v[16:19], v0, s[16:19], s81 offen offset:2048 sc1
s_mov_b64 exec, -1
K_17:
buffer_load_dwordx4 v[20:23], v0, s[16:19], s81 offen offset:3072 sc1
s_mov_b64 exec, -1
K_18:
s_waitcnt vmcnt(0)
s_branch P_12
R_24:
s_add_u32 s80, s80, 1
s_cmp_gt_u32 s80, 200000
s_cbranch_scc1 D_23
s_cmp_gt_u32 s80, 8
s_cbranch_scc1 F_25
buffer_load_dwordx2 v[16:17], v41, s[8:11], s81 offen sc1
buffer_load_dwordx2 v[18:19], v41, s[8:11], s81 offen offset:64 sc1
buffer_load_dwordx4 v[8:11], v0, s[8:11], s81 offen sc1
buffer_load_dwordx4 v[12:15], v0, s[8:11], s100 offen sc1
buffer_load_dwordx4 v[20:23], v40, s[8:11], s101 offen offset:0 sc1
buffer_load_dwordx4 v[24:27], v40, s[8:11], s101 offen offset:2048 sc1
s_waitcnt vmcnt(0)
s_branch P_22
F_25:
s_sleep 1
buffer_load_dwordx2 v[16:17], v41, s[16:19], s81 offen sc1
s_mov_b64 exec, -1
K_26:
buffer_load_dwordx2 v[18:19], v41, s[16:19], s81 offen offset:64 sc1
s_mov_b64 exec, -1
K_27:
buffer_load_dwordx4 v[8:11], v0, s[16:19], s81 offen sc1
s_mov_b64 exec, -1
K_28:
buffer_load_dwordx4 v[12:15], v0, s[16:19], s100 offen sc1
s_mov_b64 exec, -1
K_29:
buffer_load_dwordx4 v[20:23], v40, s[16:19], s101 offen offset:0 sc1
s_mov_b64 exec, -1
K_30:
buffer_load_dwordx4 v[24:27], v40, s[16:19], s101 offen offset:2048 sc1
s_mov_b64 exec, -1
K_31:
s_waitcnt vmcnt(0)
s_branch P_22
R_34:
s_add_u32 s80, s80, 1
s_cmp_gt_u32 s80, 200000
s_cbranch_scc1 D_33
s_sleep 1
buffer_load_dwordx4 v[8:11], v0, s[16:19], s81 offen offset:0 sc1
s_mov_b64 exec, -1
K_35:
buffer_load_dwordx4 v[12:15], v0, s[16:19], s81 offen offset:1024 sc1
s_mov_b64 exec, -1
K_36:
buffer_load_dwordx4 v[16:19], v0, s[16:19], s81 offen offset:2048 sc1
s_mov_b64 exec, -1
K_37:
buffer_load_dwordx4 v[20:23], v0, s[16:19], s81 offen offset:3072 sc1
s_mov_b64 exec, -1
K_38:
s_waitcnt vmcnt(0)
s_branch P_32
R_42:
s_add_u32 s80, s80, 1
s_cmp_gt_u32 s80, 200000
s_cbranch_scc1 D_41
s_sleep 1
buffer_load_dwordx4 v[24:27], v41, s[16:19], s81 offen offset:0 sc1
s_mov_b64 exec, -1
K_43:
buffer_load_dwordx4 v[28:31], v41, s[16:19], s81 offen offset:16 sc1
s_mov_b64 exec, -1
K_44:
buffer_load_dwordx4 v[8:11], v40, s[16:19], s100 offen sc1
s_mov_b64 exec, -1
K_45:
buffer_load_dwordx4 v[12:15], v42, s[16:19], s100 offen sc1
s_mov_b64 exec, -1
K_46:
buffer_load_dwordx4 v[16:19], v40, s[16:19], s101 offen sc1
s_mov_b64 exec, -1
K_47:
buffer_load_dwordx4 v[20:23], v42, s[16:19], s101 offen sc1
s_mov_b64 exec, -1
K_48:
s_waitcnt vmcnt(0)
s_branch P_40
R_52:
s_add_u32 s80, s80, 1
s_cmp_gt_u32 s80, 200000
s_cbranch_scc1 D_51
s_cmp_gt_u32 s80, 8
s_cbranch_scc1 F_53
buffer_load_dwordx4 v[8:11], v0, s[8:11], s81 offen sc1
buffer_load_dwordx4 v[12:15], v0, s[8:11], s81 offen offset:1024 sc1
s_waitcnt vmcnt(0)
s_branch P_50
F_53:
s_sleep 1
buffer_load_dwordx4 v[8:11], v0, s[16:19], s81 offen sc1
s_mov_b64 exec, -1
K_54:
buffer_load_dwordx4 v[12:15], v0, s[16:19], s81 offen offset:1024 sc1
s_mov_b64 exec, -1
K_55:
s_waitcnt vmcnt(0)
s_branch P_50
R_59:
s_add_u32 s80, s80, 1
s_cmp_gt_u32 s80, 200000
s_cbranch_scc1 D_58
s_sleep 1
buffer_load_dwordx4 v[8:11], v0, s[16:19], s81 offen offset:0 sc1
s_mov_b64 exec, -1
K_60:
buffer_load_dwordx4 v[12:15], v0, s[16:19], s81 offen offset:1024 sc1
s_mov_b64 exec, -1
K_61:
buffer_load_dwordx4 v[16:19], v0, s[16:19], s81 offen offset:2048 sc1
s_mov_b64 exec, -1
K_62:
buffer_load_dwordx4 v[20:23], v0, s[16:19], s81 offen offset:3072 sc1
s_mov_b64 exec, -1
K_63:
s_waitcnt vmcnt(0)
s_branch P_57
R_68:
s_add_u32 s80, s80, 1
s_cmp_gt_u32 s80, 200000
s_cbranch_scc1 D_67
s_cmp_gt_u32 s80, 8
s_cbranch_scc1 F_69
buffer_load_dwordx2 v[16:17], v41, s[8:11], s81 offen sc1
buffer_load_dwordx2 v[18:19], v41, s[8:11], s81 offen offset:64 sc1
buffer_load_dwordx4 v[8:11], v0, s[8:11], s81 offen sc1
buffer_load_dwordx4 v[12:15], v0, s[8:11], s100 offen sc1
s_waitcnt vmcnt(0)
s_branch P_66
F_69:
s_sleep 1
buffer_load_dwordx2 v[16:17], v41, s[16:19], s81 offen sc1
s_mov_b64 exec, -1
K_70:
buffer_load_dwordx2 v[18:19], v41, s[16:19], s81 offen offset:64 sc1
s_mov_b64 exec, -1
K_71:
buffer_load_dwordx4 v[8:11], v0, s[16:19], s81 offen sc1
s_mov_b64 exec, -1
K_72:
buffer_load_dwordx4 v[12:15], v0, s[16:19], s100 offen sc1
s_mov_b64 exec, -1
K_73:
s_waitcnt vmcnt(0)
s_branch P_66
R_77:
s_add_u32 s80, s80, 1
s_cmp_gt_u32 s80, 200000
s_cbranch_scc1 D_76
s_cmp_gt_u32 s80, 8
s_cbranch_scc1 F_78
buffer_load_dwordx2 v[12:13], v41, s[8:11], s81 offen sc1
buffer_load_dwordx4 v[8:11], v0, s[8:11], s81 offen sc1
s_waitcnt vmcnt(0)
s_branch P_75
F_78:
s_sleep 1
buffer_load_dwordx2 v[12:13], v41, s[16:19], s81 offen sc1
s_mov_b64 exec, -1
K_79:
buffer_load_dwordx4 v[8:11], v0, s[16:19], s81 offen sc1
s_mov_b64 exec, -1
K_80:
s_waitcnt vmcnt(0)
s_branch P_75
R_84:
s_add_u32 s80, s80, 1
s_cmp_gt_u32 s80, 200000
s_cbranch_scc1 D_83
s_sleep 1
buffer_load_dwordx4 v[8:11], v0, s[16:19], s81 offen offset:0 sc1
s_mov_b64 exec, -1
K_85:
buffer_load_dwordx4 v[12:15], v0, s[16:19], s81 offen offset:1024 sc1
s_mov_b64 exec, -1
K_86:
buffer_load_dwordx4 v[16:19], v0, s[16:19], s81 offen offset:2048 sc1
s_mov_b64 exec, -1
K_87:
buffer_load_dwordx4 v[20:23], v0, s[16:19], s81 offen offset:3072 sc1
s_mov_b64 exec, -1
K_88:
s_waitcnt vmcnt(0)
s_branch P_82
R_93:
s_add_u32 s80, s80, 1
s_cmp_gt_u32 s80, 200000
s_cbranch_scc1 D_92
s_cmp_gt_u32 s80, 8
s_cbranch_scc1 F_94
buffer_load_dwordx2 v[16:17], v41, s[8:11], s81 offen sc1
buffer_load_dwordx2 v[18:19], v41, s[8:11], s81 offen offset:64 sc1
buffer_load_dwordx4 v[8:11], v0, s[8:11], s81 offen sc1
buffer_load_dwordx4 v[12:15], v0, s[8:11], s100 offen sc1
s_waitcnt vmcnt(0)
s_branch P_91
F_94:
s_sleep 1
buffer_load_dwordx2 v[16:17], v41, s[16:19], s81 offen sc1
s_mov_b64 exec, -1
K_95:
buffer_load_dwordx2 v[18:19], v41, s[16:19], s81 offen offset:64 sc1
s_mov_b64 exec, -1
K_96:
buffer_load_dwordx4 v[8:11], v0, s[16:19], s81 offen sc1
s_mov_b64 exec, -1
K_97:
buffer_load_dwordx4 v[12:15], v0, s[16:19], s100 offen sc1
s_mov_b64 exec, -1
K_98:
s_waitcnt vmcnt(0)
s_branch P_91
R_101:
s_add_u32 s80, s80, 1
s_cmp_gt_u32 s80, 200000
s_cbranch_scc1 D_100
s_sleep 1
buffer_load_dwordx4 v[8:11], v0, s[16:19], s81 offen offset:0 sc1
s_mov_b64 exec, -1
K_102:
buffer_load_dwordx4 v[12:15], v0, s[16:19], s81 offen offset:1024 sc1
s_mov_b64 exec, -1
K_103:
buffer_load_dwordx4 v[16:19], v0, s[16:19], s81 offen offset:2048 sc1
s_mov_b64 exec, -1
K_104:
buffer_load_dwordx4 v[20:23], v0, s[16:19], s81 offen offset:3072 sc1
s_mov_b64 exec, -1
K_105:
s_waitcnt vmcnt(0)
s_branch P_99
R_109:
s_add_u32 s80, s80, 1
s_cmp_gt_u32 s80, 200000
s_cbranch_scc1 D_108
s_sleep 1
buffer_load_dwordx4 v[24:27], v41, s[16:19], s81 offen offset:0 sc1
s_mov_b64 exec, -1
K_110:
buffer_load_dwordx4 v[28:31], v41, s[16:19], s81 offen offset:16 sc1
s_mov_b64 exec, -1
K_111:
buffer_load_dwordx4 v[8:11], v40, s[16:19], s100 offen sc1
s_mov_b64 exec, -1
K_112:
buffer_load_dwordx4 v[12:15], v42, s[16:19], s100 offen sc1
s_mov_b64 exec, -1
K_113:
buffer_load_dwordx4 v[16:19], v40, s[16:19], s101 offen sc1
s_mov_b64 exec, -1
K_114:
buffer_load_dwordx4 v[20:23], v42, s[16:19], s101 offen sc1
s_mov_b64 exec, -1
K_115:
s_waitcnt vmcnt(0)
s_branch P_107
R_119:
s_add_u32 s80, s80, 1
s_cmp_gt_u32 s80, 200000
s_cbranch_scc1 D_118
s_cmp_gt_u32 s80, 8
s_cbranch_scc1 F_120
buffer_load_dwordx4 v[8:11], v0, s[8:11], s81 offen sc1
buffer_load_dwordx4 v[12:15], v0, s[8:11], s81 offen offset:1024 sc1
s_waitcnt vmcnt(0)
s_branch P_117
F_120:
s_sleep 1
buffer_load_dwordx4 v[8:11], v0, s[16:19], s81 offen sc1
s_mov_b64 exec, -1
K_121:
buffer_load_dwordx4 v[12:15], v0, s[16:19], s81 offen offset:1024 sc1
s_mov_b64 exec, -1
K_122:
s_waitcnt vmcnt(0)
s_branch P_117
R_126:
s_add_u32 s80, s80, 1
s_cmp_gt_u32 s80, 200000
s_cbranch_scc1 D_125
s_sleep 1
buffer_load_dwordx4 v[8:11], v0, s[16:19], s81 offen offset:0 sc1
s_mov_b64 exec, -1
K_127:
buffer_load_dwordx4 v[12:15], v0, s[16:19], s81 offen offset:1024 sc1
s_mov_b64 exec, -1
K_128:
buffer_load_dwordx4 v[16:19], v0, s[16:19], s81 offen offset:2048 sc1
s_mov_b64 exec, -1
K_129:
buffer_load_dwordx4 v[20:23], v0, s[16:19], s81 offen offset:3072 sc1
s_mov_b64 exec, -1
K_130:
s_waitcnt vmcnt(0)
s_branch P_124

.section .rodata,"a"
.p2align 6
.amdhsa_kernel interleave_layers__mha_block_cached__compressed_kv_cla__decode_kernel
  .amdhsa_next_free_vgpr 512
  .amdhsa_next_free_sgpr 102
  .amdhsa_accum_offset 256
  .amdhsa_group_segment_fixed_size 0
  .amdhsa_kernarg_size 112
  .amdhsa_user_sgpr_count 2
  .amdhsa_user_sgpr_kernarg_segment_ptr 1
  .amdhsa_system_sgpr_workgroup_id_x 1
.end_amdhsa_kernel
```
